```python
import torch

def _softmax(x, axis=-1):
    return torch.softmax(x, dim=axis)
def _gelu(x):
    return torch.nn.functional.gelu(x, approximate="tanh")
def _silu(x):
    return torch.nn.functional.silu(x)
def _sigmoid(x):
    return torch.sigmoid(x)
def _layernorm(x, axis=-1, eps=1e-5):
    m = x.mean(dim=axis, keepdim=True)
    v = x.var(dim=axis, keepdim=True, unbiased=False)
    return (x - m) / torch.sqrt(v + eps)
def _scatter_add(tgt, idx, src, axis=0):
    return tgt.clone().index_add_(axis, idx, src)
def _segment_sum(src, seg, n):
    out = torch.zeros((n,) + src.shape[1:], dtype=src.dtype)
    return out.index_add_(0, seg, src)
def _pad(x, pw):
    flat = tuple(v for pair in reversed(pw) for v in pair)
    return torch.nn.functional.pad(x, flat)

kernel_name = 'parallel_sum__mha_block_cached__glu_gated_reglu__decode'

def setup_inputs():

    _w = (lambda a: (lambda t: t.to(torch.bfloat16) if t.is_floating_point() else t)(torch.as_tensor(a)))
    def _A_setup():
        B, Sq, D = 1, 1, 512
        H, Sk, Dh = 32, 65536, 128
        return {
            "x": _w((lambda *s: torch.randn(*s, dtype=torch.bfloat16) * 0.05)(B, Sq, D)),
            "k_cache": _w((lambda *s: torch.randn(*s, dtype=torch.bfloat16) * 3.2)(B, H, Sk, Dh)),
            "v_cache": _w((lambda *s: torch.randn(*s, dtype=torch.bfloat16) * 1.6)(B, H, Sk, Dh)),
            "wq": _w((lambda *s: torch.randn(*s, dtype=torch.bfloat16) * 3.2)(D, H * Dh) * (D ** -0.5)),
            "wo": _w((lambda *s: torch.randn(*s, dtype=torch.bfloat16) * 1.6)(H * Dh, D) * ((H * Dh) ** -0.5)),
        }
    _A_in = _A_setup()

    def _B_setup():
        B, S, D, F = 1, 1, 512, 1792
        return {
            "x": _w((lambda *s: torch.randn(*s, dtype=torch.bfloat16) * 0.05)(B, S, D)),
            "W_gate": _w((lambda *s: torch.randn(*s, dtype=torch.bfloat16) * 1.6)(D, F) * (2.0 / D) ** 0.5),
            "W_up": _w((lambda *s: torch.randn(*s, dtype=torch.bfloat16) * 1.6)(D, F) * (2.0 / D) ** 0.5),
            "W_down": _w((lambda *s: torch.randn(*s, dtype=torch.bfloat16) * 1.6)(F, D) * (1.0 / F) ** 0.5),
        }
    _B_in = _B_setup()

    return {
        "A_x": _A_in["x"],
        "A_k_cache": _A_in["k_cache"],
        "A_v_cache": _A_in["v_cache"],
        "A_wq": _A_in["wq"],
        "A_wo": _A_in["wo"],
        "B_x": _B_in["x"],
        "B_W_gate": _B_in["W_gate"],
        "B_W_up": _B_in["W_up"],
        "B_W_down": _B_in["W_down"],
    }

def reference(A_x, A_k_cache, A_v_cache, A_wq, A_wo, B_x, B_W_gate, B_W_up, B_W_down):
    def _A_ref(x, k_cache, v_cache, wq, wo):
        B, Sq, D = x.shape
        H, Dh = 32, 128
        q = (lambda x, *d: x.permute(*d))((x @ wq).reshape(B, Sq, H, Dh), 0, 2, 1, 3)
        scores = torch.einsum("bhqd,bhkd->bhqk", q, k_cache) * (Dh ** -0.5)
        p = _softmax(scores, axis=-1)
        o = torch.einsum("bhqk,bhkd->bhqd", p, v_cache)
        return (lambda x, *d: x.permute(*d))(o, 0, 2, 1, 3).reshape(B, Sq, H * Dh) @ wo

    def _B_ref(x, W_gate, W_up, W_down):
        gate = torch.einsum("bsd,df->bsf", x, W_gate)
        up = torch.einsum("bsd,df->bsf", x, W_up)
        gate = gate * (lambda x, dt: x.to(dt))(gate > 0, gate.dtype)
        h = gate * up
        return torch.einsum("bsf,fd->bsd", h, W_down)

    x = A_x
    xn = _layernorm(x, axis=-1)
    return x + _A_ref(xn, A_k_cache, A_v_cache, A_wq, A_wo) + _B_ref(xn, B_W_gate, B_W_up, B_W_down)
```

```asm
; @launch grid=(256,1,1) block=(320,1,1) lds=40960
.amdgcn_target "amdgcn-amd-amdhsa--gfx950"
.text
.globl parallel_sum__mha_block_cached__glu_gated_reglu__decode_kernel
.p2align 8
.type parallel_sum__mha_block_cached__glu_gated_reglu__decode_kernel,@function
parallel_sum__mha_block_cached__glu_gated_reglu__decode_kernel:
    s_cmp_ge_u32 s2, 256
    s_cbranch_scc1 L_end
    s_load_dwordx16 s[52:67], s[0:1], 0
    s_load_dwordx8 s[68:75], s[0:1], 64
    v_lshrrev_b32 v1, 6, v0
    v_and_b32 v0, 63, v0
    s_lshr_b32 s4, s2, 3
    v_readfirstlane_b32 s3, v1
    s_and_b32 s5, s2, 7
    v_and_b32 v20, 15, v0
    v_lshrrev_b32 v21, 4, v0
    v_and_b32 v22, 1, v0
    v_mov_b32 v23, 0xffff
    v_lshlrev_b32 v22, 4, v22
    v_lshlrev_b32 v23, v22, v23
    v_lshrrev_b32 v22, 1, v20
    v_cmp_eq_u32 vcc, 0, v22
    s_nop 1
    v_cndmask_b32 v16, 0, v23, vcc
    v_cmp_eq_u32 vcc, 1, v22
    s_nop 1
    v_cndmask_b32 v17, 0, v23, vcc
    v_cmp_eq_u32 vcc, 2, v22
    s_nop 1
    v_cndmask_b32 v18, 0, v23, vcc
    v_cmp_eq_u32 vcc, 3, v22
    s_nop 1
    v_cndmask_b32 v19, 0, v23, vcc
    v_mov_b32 v2, 0
    ds_write_b32 v2, v2 offset:1280
    ds_write_b32 v2, v2 offset:1284
    s_waitcnt lgkmcnt(0)
    s_mov_b32 s16, s74
    s_mov_b32 s17, s75
    s_mov_b32 s18, 0x300000
    s_mov_b32 s19, 0x20000
    s_cmp_lg_u32 s3, 0
    s_cbranch_scc1 L_stream
    s_load_dword s40, s[74:75], 0
    s_mov_b32 s28, s52
    s_mov_b32 s29, s53
    s_mov_b32 s30, 1024
    s_mov_b32 s31, 0x20000
    s_mov_b32 s20, s58
    s_mov_b32 s21, s59
    s_mov_b32 s22, 0x400000
    s_mov_b32 s23, 0x20000
    v_lshlrev_b32 v2, 4, v0
    s_lshl_b32 s38, s5, 19
    s_lshl_b32 s39, s4, 8
    s_add_u32 s38, s38, s39
    v_lshlrev_b32 v3, 17, v21
    v_lshl_add_u32 v3, v20, 4, v3
    s_cmp_lg_u32 s5, 0
    s_cbranch_scc1 L_noinit
    s_lshl_b32 s39, s4, 9
    s_add_u32 s39, s39, 4096
    v_mov_b32 v4, 0
    v_lshlrev_b32 v5, 8, v0
    s_mov_b64 exec, 3
    buffer_store_dword v4, v5, s[16:19], s39 offen sc1
    s_mov_b64 exec, -1
L_noinit:
    buffer_load_dwordx4 v[8:11], v2, s[28:31], 0 offen
    buffer_load_dwordx4 v[64:67], v3, s[20:23], s38 offen nt
    s_add_u32 s38, s38, 8192
    buffer_load_dwordx4 v[68:71], v3, s[20:23], s38 offen nt
    s_add_u32 s38, s38, 8192
    buffer_load_dwordx4 v[72:75], v3, s[20:23], s38 offen nt
    s_add_u32 s38, s38, 8192
    buffer_load_dwordx4 v[76:79], v3, s[20:23], s38 offen nt
    s_add_u32 s38, s38, 8192
    buffer_load_dwordx4 v[80:83], v3, s[20:23], s38 offen nt
    s_add_u32 s38, s38, 8192
    buffer_load_dwordx4 v[84:87], v3, s[20:23], s38 offen nt
    s_add_u32 s38, s38, 8192
    buffer_load_dwordx4 v[88:91], v3, s[20:23], s38 offen nt
    s_add_u32 s38, s38, 8192
    buffer_load_dwordx4 v[92:95], v3, s[20:23], s38 offen nt
    s_add_u32 s38, s38, 8192
    buffer_load_dwordx4 v[96:99], v3, s[20:23], s38 offen nt
    s_add_u32 s38, s38, 8192
    buffer_load_dwordx4 v[100:103], v3, s[20:23], s38 offen nt
    s_add_u32 s38, s38, 8192
    buffer_load_dwordx4 v[104:107], v3, s[20:23], s38 offen nt
    s_add_u32 s38, s38, 8192
    buffer_load_dwordx4 v[108:111], v3, s[20:23], s38 offen nt
    s_add_u32 s38, s38, 8192
    buffer_load_dwordx4 v[112:115], v3, s[20:23], s38 offen nt
    s_add_u32 s38, s38, 8192
    buffer_load_dwordx4 v[116:119], v3, s[20:23], s38 offen nt
    s_add_u32 s38, s38, 8192
    buffer_load_dwordx4 v[120:123], v3, s[20:23], s38 offen nt
    s_add_u32 s38, s38, 8192
    buffer_load_dwordx4 v[124:127], v3, s[20:23], s38 offen nt
    s_barrier
    s_branch L_helper
L_stream:
    s_sub_u32 s3, s3, 1
    s_lshl_b32 s38, s4, 24
    s_add_u32 s76, s54, s38
    s_addc_u32 s77, s55, 0
    s_add_u32 s78, s56, s38
    s_addc_u32 s79, s57, 0
    s_mov_b32 s8, s76
    s_mov_b32 s9, s77
    s_mov_b32 s10, 0x1000000
    s_mov_b32 s11, 0x20000
    s_mov_b32 s12, s76
    s_mov_b32 s13, s77
    s_mov_b32 s14, 0x1000000
    s_mov_b32 s15, 0x20000
    v_and_b32 v7, 3, v0
    v_bfe_u32 v22, v0, 2, 2
    v_lshlrev_b32 v248, 8, v22
    v_lshl_add_u32 v248, v21, 6, v248
    v_lshl_add_u32 v248, v7, 4, v248
    v_mov_b32 v249, v248
    s_mov_b32 s24, s38
    s_lshr_b32 s35, s5, 1
    s_mul_i32 s35, s35, 10
    s_and_b32 s42, s5, 1
    s_bitcmp1_b32 s3, 0
    s_cselect_b32 s26, 20480, 0
    s_bitcmp1_b32 s3, 1
    s_cselect_b32 s47, 24576, 0
    s_xor_b32 s26, s26, s47
    s_mov_b32 s55, 2048
    s_lshr_b32 s34, s35, 1
    s_lshl_b32 s34, s34, 17
    s_xor_b32 s34, s34, s26
    s_bitcmp1_b32 s35, 0
    s_cselect_b32 s38, 16384, 0
    s_xor_b32 s34, s34, s38
    s_bitcmp1_b32 s42, 0
    s_cselect_b32 s38, 32768, 0
    s_xor_b32 s34, s34, s38
L_ph1e:
    s_lshl_b32 s64, s5, 21
    s_mul_i32 s65, s3, 0x3100
    s_and_b32 s82, s3, 2
    s_lshl_b32 s82, s82, 12
    s_sub_u32 s65, s65, s82
    s_add_u32 s64, s64, s65
    s_add_u32 s64, s64, 0x100000
    s_xor_b32 s65, s64, 0x2000
    s_mov_b32 s90, 0x7fc1a5a5
    s_mov_b32 s69, s90
    s_bitcmp1_b32 s3, 1
    s_cselect_b32 s66, s78, s76
    s_cselect_b32 s67, s79, s77
    s_barrier
    s_load_dword s68, s[66:67], s64
    s_load_dword s69, s[66:67], s65
    buffer_load_dwordx4 v[56:59], v248, s[8:11], s34 offen nt
    s_xor_b32 s39, s34, 65536
    buffer_load_dwordx4 v[60:63], v248, s[8:11], s39 offen nt
    s_xor_b32 s38, s34, 1024
    buffer_load_dwordx4 v[64:67], v248, s[8:11], s38 offen nt
    s_xor_b32 s39, s34, 66560
    buffer_load_dwordx4 v[68:71], v248, s[8:11], s39 offen nt
    s_xor_b32 s34, s34, s55
    buffer_load_dwordx4 v[72:75], v249, s[12:15], s34 offen nt
    s_xor_b32 s39, s34, 65536
    buffer_load_dwordx4 v[76:79], v249, s[12:15], s39 offen nt
    s_xor_b32 s38, s34, 1024
    buffer_load_dwordx4 v[80:83], v249, s[12:15], s38 offen nt
    s_xor_b32 s39, s34, 66560
    buffer_load_dwordx4 v[84:87], v249, s[12:15], s39 offen nt
    s_waitcnt lgkmcnt(1)
    s_lshl_b32 s39, s35, 12
    s_or_b32 s39, s39, 10
    s_lshl_b32 s38, s42, 11
    s_or_b32 s39, s39, s38
    v_writelane_b32 v252, s39, 0
    s_lshl_b32 s38, s4, 9
    s_add_u32 s38, s38, 4096
    s_add_u32 s32, s74, s38
    s_addc_u32 s33, s75, 0
    s_mov_b32 s36, 4
    s_mov_b32 s80, 0
    s_mov_b32 s81, 0
    s_mov_b32 s82, 0
    s_mov_b32 s83, -1
    s_mov_b32 s84, 1
    s_mov_b32 s85, 0
    s_mov_b32 s86, 10
    s_mov_b32 s87, 0
    v_mov_b32 v254, 6144
    v_mov_b32 v1, v248
    v_lshlrev_b32 v2, 4, v0
    v_mov_b32 v3, 0
    v_mov_b32 v4, 0xff800000
    v_mov_b32 v5, 0xff800000
    s_cmp_lg_u32 s69, s90
    s_cselect_b32 s91, 1, 0
    v_mov_b32 v253, 0xff800000
    v_mov_b32 v6, 0x3fb8aa3b
    v_mov_b32 v8, 0
    v_mov_b32 v9, 0
    v_mov_b32 v10, 0
    v_mov_b32 v11, 0
    v_lshl_add_u32 v7, v21, 2, v7
    v_lshlrev_b32 v7, 4, v7
    s_mul_i32 s27, s3, 8192
    s_add_u32 s27, s27, 8192
    v_and_b32 v250, 60, v0
    v_add_u32 v250, s27, v250
    s_waitcnt lgkmcnt(0)
    s_load_dword s40, s[74:75], 0
    s_getreg_b32 s54, hwreg(HW_REG_XCC_ID)
    s_bfe_u32 s38, s54, 0x10002
    s_xor_b32 s38, s38, s5
    s_lshr_b32 s64, s64, 13
    s_xor_b32 s38, s38, s64
    s_xor_b32 s38, s38, s91
    s_and_b32 s38, s38, 1
    s_and_b32 s39, s3, 2
    s_add_u32 s38, s38, s39
    s_mul_i32 s38, s38, 7
    s_lshl_b32 s38, 1, s38
    s_add_u32 s38, s38, 0x10000000
    v_mov_b32 v12, s38
    v_mov_b32 v13, 0
    s_mov_b64 exec, 1
    ds_add_u32 v13, v12 offset:1280
    s_mov_b64 exec, -1
    s_add_u32 s35, s35, 1
    s_lshr_b32 s34, s35, 1
    s_lshl_b32 s34, s34, 17
    s_xor_b32 s34, s34, s26
    s_bitcmp1_b32 s35, 0
    s_cselect_b32 s38, 16384, 0
    s_xor_b32 s34, s34, s38
    s_bitcmp1_b32 s42, 0
    s_cselect_b32 s38, 32768, 0
    s_xor_b32 s34, s34, s38
L_ph2e:
    s_waitcnt vmcnt(4)
    buffer_load_dwordx4 v[88:91], v248, s[8:11], s34 offen nt
    s_xor_b32 s39, s34, 65536
    buffer_load_dwordx4 v[92:95], v248, s[8:11], s39 offen nt
    s_xor_b32 s38, s34, 1024
    buffer_load_dwordx4 v[96:99], v248, s[8:11], s38 offen nt
    s_xor_b32 s39, s34, 66560
    buffer_load_dwordx4 v[100:103], v248, s[8:11], s39 offen nt
    s_waitcnt vmcnt(4)
    s_xor_b32 s34, s34, s55
    buffer_load_dwordx4 v[104:107], v249, s[12:15], s34 offen nt
    s_xor_b32 s39, s34, 65536
    buffer_load_dwordx4 v[108:111], v249, s[12:15], s39 offen nt
    s_xor_b32 s38, s34, 1024
    buffer_load_dwordx4 v[112:115], v249, s[12:15], s38 offen nt
    s_xor_b32 s39, s34, 66560
    buffer_load_dwordx4 v[116:119], v249, s[12:15], s39 offen nt
    s_add_u32 s35, s35, 1
    s_lshr_b32 s34, s35, 1
    s_lshl_b32 s34, s34, 17
    s_xor_b32 s34, s34, s26
    s_bitcmp1_b32 s35, 0
    s_cselect_b32 s38, 16384, 0
    s_xor_b32 s34, s34, s38
    s_bitcmp1_b32 s42, 0
    s_cselect_b32 s38, 32768, 0
    s_xor_b32 s34, s34, s38
L_ph3e:
    s_waitcnt vmcnt(4)
    buffer_load_dwordx4 v[120:123], v248, s[8:11], s34 offen nt
    s_xor_b32 s39, s34, 65536
    buffer_load_dwordx4 v[124:127], v248, s[8:11], s39 offen nt
    s_xor_b32 s38, s34, 1024
    buffer_load_dwordx4 v[128:131], v248, s[8:11], s38 offen nt
    s_xor_b32 s39, s34, 66560
    buffer_load_dwordx4 v[132:135], v248, s[8:11], s39 offen nt
    s_waitcnt vmcnt(4)
    s_xor_b32 s34, s34, s55
    buffer_load_dwordx4 v[136:139], v249, s[12:15], s34 offen nt
    s_xor_b32 s39, s34, 65536
    buffer_load_dwordx4 v[140:143], v249, s[12:15], s39 offen nt
    s_xor_b32 s38, s34, 1024
    buffer_load_dwordx4 v[144:147], v249, s[12:15], s38 offen nt
    s_xor_b32 s39, s34, 66560
    buffer_load_dwordx4 v[148:151], v249, s[12:15], s39 offen nt
    s_add_u32 s35, s35, 1
    s_lshr_b32 s34, s35, 1
    s_lshl_b32 s34, s34, 17
    s_xor_b32 s34, s34, s26
    s_bitcmp1_b32 s35, 0
    s_cselect_b32 s38, 16384, 0
    s_xor_b32 s34, s34, s38
    s_bitcmp1_b32 s42, 0
    s_cselect_b32 s38, 32768, 0
    s_xor_b32 s34, s34, s38
L_ph4e:
    s_waitcnt vmcnt(4)
    buffer_load_dwordx4 v[152:155], v248, s[8:11], s34 offen nt
    s_xor_b32 s39, s34, 65536
    buffer_load_dwordx4 v[156:159], v248, s[8:11], s39 offen nt
    s_xor_b32 s38, s34, 1024
    buffer_load_dwordx4 v[160:163], v248, s[8:11], s38 offen nt
    s_xor_b32 s39, s34, 66560
    buffer_load_dwordx4 v[164:167], v248, s[8:11], s39 offen nt
    s_waitcnt vmcnt(4)
    s_xor_b32 s34, s34, s55
    buffer_load_dwordx4 v[168:171], v249, s[12:15], s34 offen nt
    s_xor_b32 s39, s34, 65536
    buffer_load_dwordx4 v[172:175], v249, s[12:15], s39 offen nt
    s_xor_b32 s38, s34, 1024
    buffer_load_dwordx4 v[176:179], v249, s[12:15], s38 offen nt
    s_xor_b32 s39, s34, 66560
    buffer_load_dwordx4 v[180:183], v249, s[12:15], s39 offen nt
    s_add_u32 s35, s35, 1
    s_lshr_b32 s34, s35, 1
    s_lshl_b32 s34, s34, 17
    s_xor_b32 s34, s34, s26
    s_bitcmp1_b32 s35, 0
    s_cselect_b32 s38, 16384, 0
    s_xor_b32 s34, s34, s38
    s_bitcmp1_b32 s42, 0
    s_cselect_b32 s38, 32768, 0
    s_xor_b32 s34, s34, s38
L_ph5e:
    s_waitcnt vmcnt(4)
    buffer_load_dwordx4 v[184:187], v248, s[8:11], s34 offen nt
    s_xor_b32 s39, s34, 65536
    buffer_load_dwordx4 v[188:191], v248, s[8:11], s39 offen nt
    s_xor_b32 s38, s34, 1024
    buffer_load_dwordx4 v[192:195], v248, s[8:11], s38 offen nt
    s_xor_b32 s39, s34, 66560
    buffer_load_dwordx4 v[196:199], v248, s[8:11], s39 offen nt
    s_waitcnt vmcnt(4)
    s_xor_b32 s34, s34, s55
    buffer_load_dwordx4 v[200:203], v249, s[12:15], s34 offen nt
    s_xor_b32 s39, s34, 65536
    buffer_load_dwordx4 v[204:207], v249, s[12:15], s39 offen nt
    s_xor_b32 s38, s34, 1024
    buffer_load_dwordx4 v[208:211], v249, s[12:15], s38 offen nt
    s_xor_b32 s39, s34, 66560
    buffer_load_dwordx4 v[212:215], v249, s[12:15], s39 offen nt
    s_add_u32 s35, s35, 1
    s_lshr_b32 s34, s35, 1
    s_lshl_b32 s34, s34, 17
    s_xor_b32 s34, s34, s26
    s_bitcmp1_b32 s35, 0
    s_cselect_b32 s38, 16384, 0
    s_xor_b32 s34, s34, s38
    s_bitcmp1_b32 s42, 0
    s_cselect_b32 s38, 32768, 0
    s_xor_b32 s34, s34, s38
L_ph6e:
    s_waitcnt vmcnt(4)
    buffer_load_dwordx4 v[216:219], v248, s[8:11], s34 offen nt
    s_xor_b32 s39, s34, 65536
    buffer_load_dwordx4 v[220:223], v248, s[8:11], s39 offen nt
    s_xor_b32 s38, s34, 1024
    buffer_load_dwordx4 v[224:227], v248, s[8:11], s38 offen nt
    s_xor_b32 s39, s34, 66560
    buffer_load_dwordx4 v[228:231], v248, s[8:11], s39 offen nt
    s_waitcnt vmcnt(4)
    s_xor_b32 s34, s34, s55
    buffer_load_dwordx4 v[232:235], v249, s[12:15], s34 offen nt
    s_xor_b32 s39, s34, 65536
    buffer_load_dwordx4 v[236:239], v249, s[12:15], s39 offen nt
    s_xor_b32 s38, s34, 1024
    buffer_load_dwordx4 v[240:243], v249, s[12:15], s38 offen nt
    s_xor_b32 s39, s34, 66560
    buffer_load_dwordx4 v[244:247], v249, s[12:15], s39 offen nt
    s_add_u32 s35, s35, 1
    s_mov_b32 s56, 0
    s_bitcmp1_b32 s3, 0
    s_cselect_b32 s47, 4096, 0
    s_bitcmp1_b32 s3, 1
    s_cselect_b32 s38, 16384, 0
    s_xor_b32 s47, s47, s38
    s_waitcnt lgkmcnt(0)
    s_add_u32 s40, s40, 0x9e3779b9
    s_barrier
    ds_read_b128 v[12:15], v7 offset:1024
    s_mov_b32 s6, 0
    s_mov_b32 s7, 0
    s_waitcnt lgkmcnt(0)
    v_cmp_eq_u32 vcc, 0, v22
    s_nop 1
    v_cndmask_b32 v24, 0, v12, vcc
    v_cndmask_b32 v25, 0, v13, vcc
    v_cndmask_b32 v26, 0, v14, vcc
    v_cndmask_b32 v27, 0, v15, vcc
    v_cmp_eq_u32 vcc, 1, v22
    s_nop 1
    v_cndmask_b32 v28, 0, v12, vcc
    v_cndmask_b32 v29, 0, v13, vcc
    v_cndmask_b32 v30, 0, v14, vcc
    v_cndmask_b32 v31, 0, v15, vcc
    v_cmp_eq_u32 vcc, 2, v22
    s_nop 1
    v_cndmask_b32 v32, 0, v12, vcc
    v_cndmask_b32 v33, 0, v13, vcc
    v_cndmask_b32 v34, 0, v14, vcc
    v_cndmask_b32 v35, 0, v15, vcc
    v_cmp_eq_u32 vcc, 3, v22
    s_nop 1
    v_cndmask_b32 v36, 0, v12, vcc
    v_cndmask_b32 v37, 0, v13, vcc
    v_cndmask_b32 v38, 0, v14, vcc
    v_cndmask_b32 v39, 0, v15, vcc
    s_nop 1
    s_waitcnt vmcnt(44)
    v_mfma_f32_16x16x32_bf16 v[12:15], v[56:59], v[24:27], 0
    v_mfma_f32_16x16x32_bf16 v[12:15], v[60:63], v[28:31], v[12:15]
    v_mfma_f32_16x16x32_bf16 v[12:15], v[64:67], v[32:35], v[12:15]
    v_mfma_f32_16x16x32_bf16 v[12:15], v[68:71], v[36:39], v[12:15]
    s_cmp_lg_u32 s36, 0
    s_cbranch_scc1 L_x7
    s_call_b64 s[88:89], L_switch
L_x7:
    s_lshr_b32 s34, s35, 1
    s_lshl_b32 s34, s34, 17
    s_xor_b32 s34, s34, s56
    s_lshr_b32 s39, s35, 5
    s_bitcmp1_b32 s7, s39
    s_cbranch_scc0 L_ph8m
    s_cmp_lt_u32 s35, 40
    s_cbranch_scc1 L_ph8m
    s_lshr_b32 s39, s6, s39
    s_xor_b32 s39, s39, s42
    s_and_b32 s39, s39, 1
    s_lshl_b32 s39, s39, 13
    s_xor_b32 s34, s34, s39
    s_xor_b32 s34, s34, s47
    s_bitcmp1_b32 s35, 0
    s_cselect_b32 s38, 32768, 0
    s_xor_b32 s34, s34, s38
    s_branch L_ph8e
L_ph8m:
    s_xor_b32 s34, s34, s26
    s_bitcmp1_b32 s35, 0
    s_cselect_b32 s38, 16384, 0
    s_xor_b32 s34, s34, s38
    s_bitcmp1_b32 s42, 0
    s_cselect_b32 s38, 32768, 0
    s_xor_b32 s34, s34, s38
L_ph8e:
    buffer_load_dwordx4 v[56:59], v248, s[8:11], s34 offen nt
    s_xor_b32 s39, s34, 65536
    buffer_load_dwordx4 v[60:63], v248, s[8:11], s39 offen nt
    s_xor_b32 s38, s34, 1024
    buffer_load_dwordx4 v[64:67], v248, s[8:11], s38 offen nt
    s_xor_b32 s39, s34, 66560
    buffer_load_dwordx4 v[68:71], v248, s[8:11], s39 offen nt
    s_waitcnt vmcnt(44)
    v_mfma_f32_16x16x32_bf16 v[40:43], v[72:75], v[24:27], 0
    v_mfma_f32_16x16x32_bf16 v[40:43], v[76:79], v[28:31], v[40:43]
    v_mfma_f32_16x16x32_bf16 v[40:43], v[80:83], v[32:35], v[40:43]
    v_mfma_f32_16x16x32_bf16 v[40:43], v[84:87], v[36:39], v[40:43]
    s_xor_b32 s34, s34, s55
    buffer_load_dwordx4 v[72:75], v249, s[12:15], s34 offen nt
    s_xor_b32 s39, s34, 65536
    buffer_load_dwordx4 v[76:79], v249, s[12:15], s39 offen nt
    s_xor_b32 s38, s34, 1024
    buffer_load_dwordx4 v[80:83], v249, s[12:15], s38 offen nt
    s_xor_b32 s39, s34, 66560
    buffer_load_dwordx4 v[84:87], v249, s[12:15], s39 offen nt
    s_add_u32 s35, s35, 1
    s_mov_b32 s44, s80
    s_and_b32 s80, s80, 3
    s_sub_u32 s36, s36, 1
    s_cmp_lg_u32 s36, s82
    s_cbranch_scc1 L_na9
    s_call_b64 s[90:91], L_claim
L_na9:
    s_cmp_lg_u32 s36, s83
    s_cbranch_scc1 L_na9p
    s_call_b64 s[90:91], L_publish
L_na9p:
    v_mov_b32_dpp v20, v12 quad_perm:[0,0,0,0] row_mask:0xf bank_mask:0xf
    v_mov_b32_dpp v22, v14 quad_perm:[2,2,2,2] row_mask:0xf bank_mask:0xf
    s_nop 0
    v_add_f32_dpp v20, v13, v20 quad_perm:[1,1,1,1] row_mask:0xf bank_mask:0xf
    v_add_f32_dpp v22, v15, v22 quad_perm:[3,3,3,3] row_mask:0xf bank_mask:0xf
    v_add_f32 v20, v20, v22
    v_mov_b32_dpp v21, v40 quad_perm:[0,0,0,0] row_mask:0xf bank_mask:0xf
    v_mov_b32_dpp v22, v42 quad_perm:[2,2,2,2] row_mask:0xf bank_mask:0xf
    s_nop 0
    v_add_f32_dpp v21, v41, v21 quad_perm:[1,1,1,1] row_mask:0xf bank_mask:0xf
    v_add_f32_dpp v22, v43, v22 quad_perm:[3,3,3,3] row_mask:0xf bank_mask:0xf
    v_add_f32 v21, v21, v22
    v_cvt_pk_bf16_f32 v22, v20, v21
    v_lshlrev_b32 v20, 16, v22
    v_and_b32 v21, 0xffff0000, v22
    v_mul_f32 v20, 0x3db504f3, v20
    v_mul_f32 v21, 0x3db504f3, v21
    v_cvt_pk_bf16_f32 v22, v20, v21
    ds_write_b32 v250, v22
    v_add_u32 v250, 64, v250
    v_lshlrev_b32 v20, 16, v22
    v_and_b32 v21, 0xffff0000, v22
    v_max3_f32 v253, v20, v21, v253
    s_waitcnt vmcnt(44)
    v_mfma_f32_16x16x32_bf16 v[12:15], v[88:91], v[24:27], 0
    v_mfma_f32_16x16x32_bf16 v[12:15], v[92:95], v[28:31], v[12:15]
    v_mfma_f32_16x16x32_bf16 v[12:15], v[96:99], v[32:35], v[12:15]
    v_mfma_f32_16x16x32_bf16 v[12:15], v[100:103], v[36:39], v[12:15]
    s_cmp_lg_u32 s36, 0
    s_cbranch_scc1 L_x10
    s_call_b64 s[88:89], L_switch
L_x10:
    s_lshr_b32 s34, s35, 1
    s_lshl_b32 s34, s34, 17
    s_xor_b32 s34, s34, s56
    s_lshr_b32 s39, s35, 5
    s_bitcmp1_b32 s7, s39
    s_cbranch_scc0 L_ph11m
    s_cmp_lt_u32 s35, 40
    s_cbranch_scc1 L_ph11m
    s_lshr_b32 s39, s6, s39
    s_xor_b32 s39, s39, s42
    s_and_b32 s39, s39, 1
    s_lshl_b32 s39, s39, 13
    s_xor_b32 s34, s34, s39
    s_xor_b32 s34, s34, s47
    s_bitcmp1_b32 s35, 0
    s_cselect_b32 s38, 32768, 0
    s_xor_b32 s34, s34, s38
    s_branch L_ph11e
L_ph11m:
    s_xor_b32 s34, s34, s26
    s_bitcmp1_b32 s35, 0
    s_cselect_b32 s38, 16384, 0
    s_xor_b32 s34, s34, s38
    s_bitcmp1_b32 s42, 0
    s_cselect_b32 s38, 32768, 0
    s_xor_b32 s34, s34, s38
L_ph11e:
    buffer_load_dwordx4 v[88:91], v248, s[8:11], s34 offen nt
    s_xor_b32 s39, s34, 65536
    buffer_load_dwordx4 v[92:95], v248, s[8:11], s39 offen nt
    s_xor_b32 s38, s34, 1024
    buffer_load_dwordx4 v[96:99], v248, s[8:11], s38 offen nt
    s_xor_b32 s39, s34, 66560
    buffer_load_dwordx4 v[100:103], v248, s[8:11], s39 offen nt
    s_waitcnt vmcnt(44)
    v_mfma_f32_16x16x32_bf16 v[40:43], v[104:107], v[24:27], 0
    v_mfma_f32_16x16x32_bf16 v[40:43], v[108:111], v[28:31], v[40:43]
    v_mfma_f32_16x16x32_bf16 v[40:43], v[112:115], v[32:35], v[40:43]
    v_mfma_f32_16x16x32_bf16 v[40:43], v[116:119], v[36:39], v[40:43]
    s_xor_b32 s34, s34, s55
    buffer_load_dwordx4 v[104:107], v249, s[12:15], s34 offen nt
    s_xor_b32 s39, s34, 65536
    buffer_load_dwordx4 v[108:111], v249, s[12:15], s39 offen nt
    s_xor_b32 s38, s34, 1024
    buffer_load_dwordx4 v[112:115], v249, s[12:15], s38 offen nt
    s_xor_b32 s39, s34, 66560
    buffer_load_dwordx4 v[116:119], v249, s[12:15], s39 offen nt
    s_add_u32 s35, s35, 1
    s_mov_b32 s45, s80
    s_and_b32 s80, s80, 3
    s_sub_u32 s36, s36, 1
    s_cmp_lg_u32 s36, s82
    s_cbranch_scc1 L_na12
    s_call_b64 s[90:91], L_claim
L_na12:
    s_cmp_lg_u32 s36, s83
    s_cbranch_scc1 L_na12p
    s_call_b64 s[90:91], L_publish
L_na12p:
    v_mov_b32_dpp v20, v12 quad_perm:[0,0,0,0] row_mask:0xf bank_mask:0xf
    v_mov_b32_dpp v22, v14 quad_perm:[2,2,2,2] row_mask:0xf bank_mask:0xf
    s_nop 0
    v_add_f32_dpp v20, v13, v20 quad_perm:[1,1,1,1] row_mask:0xf bank_mask:0xf
    v_add_f32_dpp v22, v15, v22 quad_perm:[3,3,3,3] row_mask:0xf bank_mask:0xf
    v_add_f32 v20, v20, v22
    v_mov_b32_dpp v21, v40 quad_perm:[0,0,0,0] row_mask:0xf bank_mask:0xf
    v_mov_b32_dpp v22, v42 quad_perm:[2,2,2,2] row_mask:0xf bank_mask:0xf
    s_nop 0
    v_add_f32_dpp v21, v41, v21 quad_perm:[1,1,1,1] row_mask:0xf bank_mask:0xf
    v_add_f32_dpp v22, v43, v22 quad_perm:[3,3,3,3] row_mask:0xf bank_mask:0xf
    v_add_f32 v21, v21, v22
    v_cvt_pk_bf16_f32 v22, v20, v21
    v_lshlrev_b32 v20, 16, v22
    v_and_b32 v21, 0xffff0000, v22
    v_mul_f32 v20, 0x3db504f3, v20
    v_mul_f32 v21, 0x3db504f3, v21
    v_cvt_pk_bf16_f32 v22, v20, v21
    ds_write_b32 v250, v22
    v_add_u32 v250, 64, v250
    v_lshlrev_b32 v20, 16, v22
    v_and_b32 v21, 0xffff0000, v22
    v_max3_f32 v253, v20, v21, v253
    s_waitcnt vmcnt(44)
    v_mfma_f32_16x16x32_bf16 v[12:15], v[120:123], v[24:27], 0
    v_mfma_f32_16x16x32_bf16 v[12:15], v[124:127], v[28:31], v[12:15]
    v_mfma_f32_16x16x32_bf16 v[12:15], v[128:131], v[32:35], v[12:15]
    v_mfma_f32_16x16x32_bf16 v[12:15], v[132:135], v[36:39], v[12:15]
    s_waitcnt vmcnt(40)
    v_mfma_f32_16x16x32_bf16 v[40:43], v[136:139], v[24:27], 0
    v_mfma_f32_16x16x32_bf16 v[40:43], v[140:143], v[28:31], v[40:43]
    v_mfma_f32_16x16x32_bf16 v[40:43], v[144:147], v[32:35], v[40:43]
    v_mfma_f32_16x16x32_bf16 v[40:43], v[148:151], v[36:39], v[40:43]
    s_nop 2
    v_mov_b32_dpp v20, v12 quad_perm:[0,0,0,0] row_mask:0xf bank_mask:0xf
    v_mov_b32_dpp v22, v14 quad_perm:[2,2,2,2] row_mask:0xf bank_mask:0xf
    s_nop 0
    v_add_f32_dpp v20, v13, v20 quad_perm:[1,1,1,1] row_mask:0xf bank_mask:0xf
    v_add_f32_dpp v22, v15, v22 quad_perm:[3,3,3,3] row_mask:0xf bank_mask:0xf
    v_add_f32 v20, v20, v22
    v_mov_b32_dpp v21, v40 quad_perm:[0,0,0,0] row_mask:0xf bank_mask:0xf
    v_mov_b32_dpp v22, v42 quad_perm:[2,2,2,2] row_mask:0xf bank_mask:0xf
    s_nop 0
    v_add_f32_dpp v21, v41, v21 quad_perm:[1,1,1,1] row_mask:0xf bank_mask:0xf
    v_add_f32_dpp v22, v43, v22 quad_perm:[3,3,3,3] row_mask:0xf bank_mask:0xf
    v_add_f32 v21, v21, v22
    v_cvt_pk_bf16_f32 v22, v20, v21
    v_lshlrev_b32 v20, 16, v22
    v_and_b32 v21, 0xffff0000, v22
    v_mul_f32 v20, 0x3db504f3, v20
    v_mul_f32 v21, 0x3db504f3, v21
    v_cvt_pk_bf16_f32 v22, v20, v21
    ds_write_b32 v250, v22
    v_add_u32 v250, 64, v250
    v_lshlrev_b32 v20, 16, v22
    v_and_b32 v21, 0xffff0000, v22
    v_max3_f32 v253, v20, v21, v253
    s_waitcnt vmcnt(36)
    v_mfma_f32_16x16x32_bf16 v[12:15], v[152:155], v[24:27], 0
    v_mfma_f32_16x16x32_bf16 v[12:15], v[156:159], v[28:31], v[12:15]
    v_mfma_f32_16x16x32_bf16 v[12:15], v[160:163], v[32:35], v[12:15]
    v_mfma_f32_16x16x32_bf16 v[12:15], v[164:167], v[36:39], v[12:15]
    s_waitcnt vmcnt(32)
    v_mfma_f32_16x16x32_bf16 v[40:43], v[168:171], v[24:27], 0
    v_mfma_f32_16x16x32_bf16 v[40:43], v[172:175], v[28:31], v[40:43]
    v_mfma_f32_16x16x32_bf16 v[40:43], v[176:179], v[32:35], v[40:43]
    v_mfma_f32_16x16x32_bf16 v[40:43], v[180:183], v[36:39], v[40:43]
    s_nop 2
    v_mov_b32_dpp v20, v12 quad_perm:[0,0,0,0] row_mask:0xf bank_mask:0xf
    v_mov_b32_dpp v22, v14 quad_perm:[2,2,2,2] row_mask:0xf bank_mask:0xf
    s_nop 0
    v_add_f32_dpp v20, v13, v20 quad_perm:[1,1,1,1] row_mask:0xf bank_mask:0xf
    v_add_f32_dpp v22, v15, v22 quad_perm:[3,3,3,3] row_mask:0xf bank_mask:0xf
    v_add_f32 v20, v20, v22
    v_mov_b32_dpp v21, v40 quad_perm:[0,0,0,0] row_mask:0xf bank_mask:0xf
    v_mov_b32_dpp v22, v42 quad_perm:[2,2,2,2] row_mask:0xf bank_mask:0xf
    s_nop 0
    v_add_f32_dpp v21, v41, v21 quad_perm:[1,1,1,1] row_mask:0xf bank_mask:0xf
    v_add_f32_dpp v22, v43, v22 quad_perm:[3,3,3,3] row_mask:0xf bank_mask:0xf
    v_add_f32 v21, v21, v22
    v_cvt_pk_bf16_f32 v22, v20, v21
    v_lshlrev_b32 v20, 16, v22
    v_and_b32 v21, 0xffff0000, v22
    v_mul_f32 v20, 0x3db504f3, v20
    v_mul_f32 v21, 0x3db504f3, v21
    v_cvt_pk_bf16_f32 v22, v20, v21
    ds_write_b32 v250, v22
    v_add_u32 v250, 64, v250
    v_lshlrev_b32 v20, 16, v22
    v_and_b32 v21, 0xffff0000, v22
    v_max3_f32 v253, v20, v21, v253
    s_waitcnt vmcnt(28)
    v_mfma_f32_16x16x32_bf16 v[12:15], v[184:187], v[24:27], 0
    v_mfma_f32_16x16x32_bf16 v[12:15], v[188:191], v[28:31], v[12:15]
    v_mfma_f32_16x16x32_bf16 v[12:15], v[192:195], v[32:35], v[12:15]
    v_mfma_f32_16x16x32_bf16 v[12:15], v[196:199], v[36:39], v[12:15]
    s_waitcnt vmcnt(24)
    v_mfma_f32_16x16x32_bf16 v[40:43], v[200:203], v[24:27], 0
    v_mfma_f32_16x16x32_bf16 v[40:43], v[204:207], v[28:31], v[40:43]
    v_mfma_f32_16x16x32_bf16 v[40:43], v[208:211], v[32:35], v[40:43]
    v_mfma_f32_16x16x32_bf16 v[40:43], v[212:215], v[36:39], v[40:43]
    s_nop 2
    v_mov_b32_dpp v20, v12 quad_perm:[0,0,0,0] row_mask:0xf bank_mask:0xf
    v_mov_b32_dpp v22, v14 quad_perm:[2,2,2,2] row_mask:0xf bank_mask:0xf
    s_nop 0
    v_add_f32_dpp v20, v13, v20 quad_perm:[1,1,1,1] row_mask:0xf bank_mask:0xf
    v_add_f32_dpp v22, v15, v22 quad_perm:[3,3,3,3] row_mask:0xf bank_mask:0xf
    v_add_f32 v20, v20, v22
    v_mov_b32_dpp v21, v40 quad_perm:[0,0,0,0] row_mask:0xf bank_mask:0xf
    v_mov_b32_dpp v22, v42 quad_perm:[2,2,2,2] row_mask:0xf bank_mask:0xf
    s_nop 0
    v_add_f32_dpp v21, v41, v21 quad_perm:[1,1,1,1] row_mask:0xf bank_mask:0xf
    v_add_f32_dpp v22, v43, v22 quad_perm:[3,3,3,3] row_mask:0xf bank_mask:0xf
    v_add_f32 v21, v21, v22
    v_cvt_pk_bf16_f32 v22, v20, v21
    v_lshlrev_b32 v20, 16, v22
    v_and_b32 v21, 0xffff0000, v22
    v_mul_f32 v20, 0x3db504f3, v20
    v_mul_f32 v21, 0x3db504f3, v21
    v_cvt_pk_bf16_f32 v22, v20, v21
    ds_write_b32 v250, v22
    v_add_u32 v250, 64, v250
    v_lshlrev_b32 v20, 16, v22
    v_and_b32 v21, 0xffff0000, v22
    v_max3_f32 v253, v20, v21, v253
    s_waitcnt vmcnt(20)
    v_mfma_f32_16x16x32_bf16 v[12:15], v[216:219], v[24:27], 0
    v_mfma_f32_16x16x32_bf16 v[12:15], v[220:223], v[28:31], v[12:15]
    v_mfma_f32_16x16x32_bf16 v[12:15], v[224:227], v[32:35], v[12:15]
    v_mfma_f32_16x16x32_bf16 v[12:15], v[228:231], v[36:39], v[12:15]
    s_waitcnt vmcnt(16)
    v_mfma_f32_16x16x32_bf16 v[40:43], v[232:235], v[24:27], 0
    v_mfma_f32_16x16x32_bf16 v[40:43], v[236:239], v[28:31], v[40:43]
    v_mfma_f32_16x16x32_bf16 v[40:43], v[240:243], v[32:35], v[40:43]
    v_mfma_f32_16x16x32_bf16 v[40:43], v[244:247], v[36:39], v[40:43]
    s_nop 2
    v_mov_b32_dpp v20, v12 quad_perm:[0,0,0,0] row_mask:0xf bank_mask:0xf
    v_mov_b32_dpp v22, v14 quad_perm:[2,2,2,2] row_mask:0xf bank_mask:0xf
    s_nop 0
    v_add_f32_dpp v20, v13, v20 quad_perm:[1,1,1,1] row_mask:0xf bank_mask:0xf
    v_add_f32_dpp v22, v15, v22 quad_perm:[3,3,3,3] row_mask:0xf bank_mask:0xf
    v_add_f32 v20, v20, v22
    v_mov_b32_dpp v21, v40 quad_perm:[0,0,0,0] row_mask:0xf bank_mask:0xf
    v_mov_b32_dpp v22, v42 quad_perm:[2,2,2,2] row_mask:0xf bank_mask:0xf
    s_nop 0
    v_add_f32_dpp v21, v41, v21 quad_perm:[1,1,1,1] row_mask:0xf bank_mask:0xf
    v_add_f32_dpp v22, v43, v22 quad_perm:[3,3,3,3] row_mask:0xf bank_mask:0xf
    v_add_f32 v21, v21, v22
    v_cvt_pk_bf16_f32 v22, v20, v21
    v_lshlrev_b32 v20, 16, v22
    v_and_b32 v21, 0xffff0000, v22
    v_mul_f32 v20, 0x3db504f3, v20
    v_mul_f32 v21, 0x3db504f3, v21
    v_cvt_pk_bf16_f32 v22, v20, v21
    ds_write_b32 v250, v22
    v_add_u32 v250, 64, v250
    v_lshlrev_b32 v20, 16, v22
    v_and_b32 v21, 0xffff0000, v22
    v_max3_f32 v253, v20, v21, v253
    s_lshl_b32 s38, s2, 14
    s_lshl_b32 s39, s3, 8
    s_add_u32 s38, s38, s39
    s_mov_b32 s20, s60
    s_mov_b32 s21, s61
    s_mov_b32 s22, 0x400000
    s_mov_b32 s23, 0x20000
    v_lshlrev_b32 v7, 2, v0
    buffer_load_dword v216, v7, s[20:23], s38 offen offset:0 nt
    buffer_load_dword v217, v7, s[20:23], s38 offen offset:1024 nt
    buffer_load_dword v218, v7, s[20:23], s38 offen offset:2048 nt
    buffer_load_dword v219, v7, s[20:23], s38 offen offset:3072 nt
    s_add_u32 s38, s38, 4096
    buffer_load_dword v220, v7, s[20:23], s38 offen offset:0 nt
    buffer_load_dword v221, v7, s[20:23], s38 offen offset:1024 nt
    buffer_load_dword v222, v7, s[20:23], s38 offen offset:2048 nt
    buffer_load_dword v223, v7, s[20:23], s38 offen offset:3072 nt
    s_add_u32 s38, s38, 4096
    buffer_load_dword v224, v7, s[20:23], s38 offen offset:0 nt
    buffer_load_dword v225, v7, s[20:23], s38 offen offset:1024 nt
    buffer_load_dword v226, v7, s[20:23], s38 offen offset:2048 nt
    buffer_load_dword v227, v7, s[20:23], s38 offen offset:3072 nt
    s_add_u32 s38, s38, 4096
    buffer_load_dword v228, v7, s[20:23], s38 offen offset:0 nt
    buffer_load_dword v229, v7, s[20:23], s38 offen offset:1024 nt
    buffer_load_dword v230, v7, s[20:23], s38 offen offset:2048 nt
    buffer_load_dword v231, v7, s[20:23], s38 offen offset:3072 nt
    v_mov_b32 v20, 0
    s_mov_b32 s41, 6400000
L_plw:
    ds_read_b32 v21, v20 offset:1284
    s_sub_u32 s41, s41, 1
    s_waitcnt lgkmcnt(0)
    v_readfirstlane_b32 s6, v21
    s_cmp_eq_u32 s41, 0
    s_cbranch_scc1 L_plx
    s_cmp_eq_u32 s6, 0
    s_cbranch_scc1 L_plw
L_plx:
    s_bfe_u32 s54, s54, 0x10002
    s_lshl_b32 s54, s54, 4
    s_bfe_u32 s7, s6, 0x80008
    s_cselect_b32 s54, s54, 0
    s_waitcnt vmcnt(28)
    v_mfma_f32_16x16x32_bf16 v[12:15], v[56:59], v[24:27], 0
    v_mfma_f32_16x16x32_bf16 v[12:15], v[60:63], v[28:31], v[12:15]
    v_mfma_f32_16x16x32_bf16 v[12:15], v[64:67], v[32:35], v[12:15]
    v_mfma_f32_16x16x32_bf16 v[12:15], v[68:71], v[36:39], v[12:15]
    s_cmp_lg_u32 s36, 0
    s_cbranch_scc1 L_x13
    s_call_b64 s[88:89], L_switch
L_x13:
    s_lshr_b32 s34, s35, 1
    s_lshl_b32 s34, s34, 17
    s_xor_b32 s34, s34, s56
    s_lshr_b32 s39, s35, 5
    s_bitcmp1_b32 s7, s39
    s_cbranch_scc0 L_ph14m
    s_cmp_lt_u32 s35, 40
    s_cbranch_scc1 L_ph14m
    s_lshr_b32 s39, s6, s39
    s_xor_b32 s39, s39, s42
    s_and_b32 s39, s39, 1
    s_lshl_b32 s39, s39, 13
    s_xor_b32 s34, s34, s39
    s_xor_b32 s34, s34, s47
    s_bitcmp1_b32 s35, 0
    s_cselect_b32 s38, 32768, 0
    s_xor_b32 s34, s34, s38
    s_branch L_ph14e
L_ph14m:
    s_xor_b32 s34, s34, s26
    s_bitcmp1_b32 s35, 0
    s_cselect_b32 s38, 16384, 0
    s_xor_b32 s34, s34, s38
    s_bitcmp1_b32 s42, 0
    s_cselect_b32 s38, 32768, 0
    s_xor_b32 s34, s34, s38
L_ph14e:
    buffer_load_dwordx4 v[56:59], v248, s[8:11], s34 offen nt
    s_xor_b32 s39, s34, 65536
    buffer_load_dwordx4 v[60:63], v248, s[8:11], s39 offen nt
    s_xor_b32 s38, s34, 1024
    buffer_load_dwordx4 v[64:67], v248, s[8:11], s38 offen nt
    s_xor_b32 s39, s34, 66560
    buffer_load_dwordx4 v[68:71], v248, s[8:11], s39 offen nt
    s_waitcnt vmcnt(28)
    v_mfma_f32_16x16x32_bf16 v[40:43], v[72:75], v[24:27], 0
    v_mfma_f32_16x16x32_bf16 v[40:43], v[76:79], v[28:31], v[40:43]
    v_mfma_f32_16x16x32_bf16 v[40:43], v[80:83], v[32:35], v[40:43]
    v_mfma_f32_16x16x32_bf16 v[40:43], v[84:87], v[36:39], v[40:43]
    s_xor_b32 s34, s34, s55
    buffer_load_dwordx4 v[72:75], v249, s[12:15], s34 offen nt
    s_xor_b32 s39, s34, 65536
    buffer_load_dwordx4 v[76:79], v249, s[12:15], s39 offen nt
    s_xor_b32 s38, s34, 1024
    buffer_load_dwordx4 v[80:83], v249, s[12:15], s38 offen nt
    s_xor_b32 s39, s34, 66560
    buffer_load_dwordx4 v[84:87], v249, s[12:15], s39 offen nt
    s_add_u32 s35, s35, 1
    s_mov_b32 s44, s80
    s_and_b32 s80, s80, 3
    s_sub_u32 s36, s36, 1
    s_cmp_lg_u32 s36, s82
    s_cbranch_scc1 L_na15
    s_call_b64 s[90:91], L_claim
L_na15:
    s_cmp_lg_u32 s36, s83
    s_cbranch_scc1 L_na15p
    s_call_b64 s[90:91], L_publish
L_na15p:
    v_mov_b32_dpp v20, v12 quad_perm:[0,0,0,0] row_mask:0xf bank_mask:0xf
    v_mov_b32_dpp v22, v14 quad_perm:[2,2,2,2] row_mask:0xf bank_mask:0xf
    s_nop 0
    v_add_f32_dpp v20, v13, v20 quad_perm:[1,1,1,1] row_mask:0xf bank_mask:0xf
    v_add_f32_dpp v22, v15, v22 quad_perm:[3,3,3,3] row_mask:0xf bank_mask:0xf
    v_add_f32 v20, v20, v22
    v_mov_b32_dpp v21, v40 quad_perm:[0,0,0,0] row_mask:0xf bank_mask:0xf
    v_mov_b32_dpp v22, v42 quad_perm:[2,2,2,2] row_mask:0xf bank_mask:0xf
    s_nop 0
    v_add_f32_dpp v21, v41, v21 quad_perm:[1,1,1,1] row_mask:0xf bank_mask:0xf
    v_add_f32_dpp v22, v43, v22 quad_perm:[3,3,3,3] row_mask:0xf bank_mask:0xf
    v_add_f32 v21, v21, v22
    v_cvt_pk_bf16_f32 v22, v20, v21
    v_lshlrev_b32 v20, 16, v22
    v_and_b32 v21, 0xffff0000, v22
    v_mul_f32 v20, 0x3db504f3, v20
    v_mul_f32 v21, 0x3db504f3, v21
    v_cvt_pk_bf16_f32 v22, v20, v21
    ds_write_b32 v250, v22
    v_add_u32 v250, 64, v250
    v_lshlrev_b32 v20, 16, v22
    v_and_b32 v21, 0xffff0000, v22
    v_max3_f32 v253, v20, v21, v253
    s_waitcnt vmcnt(28)
    v_mfma_f32_16x16x32_bf16 v[12:15], v[88:91], v[24:27], 0
    v_mfma_f32_16x16x32_bf16 v[12:15], v[92:95], v[28:31], v[12:15]
    v_mfma_f32_16x16x32_bf16 v[12:15], v[96:99], v[32:35], v[12:15]
    v_mfma_f32_16x16x32_bf16 v[12:15], v[100:103], v[36:39], v[12:15]
    s_cmp_lg_u32 s36, 0
    s_cbranch_scc1 L_x16
    s_call_b64 s[88:89], L_switch
L_x16:
    s_lshr_b32 s34, s35, 1
    s_lshl_b32 s34, s34, 17
    s_xor_b32 s34, s34, s56
    s_lshr_b32 s39, s35, 5
    s_bitcmp1_b32 s7, s39
    s_cbranch_scc0 L_ph17m
    s_cmp_lt_u32 s35, 40
    s_cbranch_scc1 L_ph17m
    s_lshr_b32 s39, s6, s39
    s_xor_b32 s39, s39, s42
    s_and_b32 s39, s39, 1
    s_lshl_b32 s39, s39, 13
    s_xor_b32 s34, s34, s39
    s_xor_b32 s34, s34, s47
    s_bitcmp1_b32 s35, 0
    s_cselect_b32 s38, 32768, 0
    s_xor_b32 s34, s34, s38
    s_branch L_ph17e
L_ph17m:
    s_xor_b32 s34, s34, s26
    s_bitcmp1_b32 s35, 0
    s_cselect_b32 s38, 16384, 0
    s_xor_b32 s34, s34, s38
    s_bitcmp1_b32 s42, 0
    s_cselect_b32 s38, 32768, 0
    s_xor_b32 s34, s34, s38
L_ph17e:
    buffer_load_dwordx4 v[88:91], v248, s[8:11], s34 offen nt
    s_xor_b32 s39, s34, 65536
    buffer_load_dwordx4 v[92:95], v248, s[8:11], s39 offen nt
    s_xor_b32 s38, s34, 1024
    buffer_load_dwordx4 v[96:99], v248, s[8:11], s38 offen nt
    s_xor_b32 s39, s34, 66560
    buffer_load_dwordx4 v[100:103], v248, s[8:11], s39 offen nt
    s_waitcnt vmcnt(28)
    v_mfma_f32_16x16x32_bf16 v[40:43], v[104:107], v[24:27], 0
    v_mfma_f32_16x16x32_bf16 v[40:43], v[108:111], v[28:31], v[40:43]
    v_mfma_f32_16x16x32_bf16 v[40:43], v[112:115], v[32:35], v[40:43]
    v_mfma_f32_16x16x32_bf16 v[40:43], v[116:119], v[36:39], v[40:43]
    s_xor_b32 s34, s34, s55
    buffer_load_dwordx4 v[104:107], v249, s[12:15], s34 offen nt
    s_xor_b32 s39, s34, 65536
    buffer_load_dwordx4 v[108:111], v249, s[12:15], s39 offen nt
    s_xor_b32 s38, s34, 1024
    buffer_load_dwordx4 v[112:115], v249, s[12:15], s38 offen nt
    s_xor_b32 s39, s34, 66560
    buffer_load_dwordx4 v[116:119], v249, s[12:15], s39 offen nt
    s_add_u32 s35, s35, 1
    s_mov_b32 s45, s80
    s_and_b32 s80, s80, 3
    s_sub_u32 s36, s36, 1
    s_cmp_lg_u32 s36, s82
    s_cbranch_scc1 L_na18
    s_call_b64 s[90:91], L_claim
L_na18:
    s_cmp_lg_u32 s36, s83
    s_cbranch_scc1 L_na18p
    s_call_b64 s[90:91], L_publish
L_na18p:
    v_mov_b32_dpp v20, v12 quad_perm:[0,0,0,0] row_mask:0xf bank_mask:0xf
    v_mov_b32_dpp v22, v14 quad_perm:[2,2,2,2] row_mask:0xf bank_mask:0xf
    s_nop 0
    v_add_f32_dpp v20, v13, v20 quad_perm:[1,1,1,1] row_mask:0xf bank_mask:0xf
    v_add_f32_dpp v22, v15, v22 quad_perm:[3,3,3,3] row_mask:0xf bank_mask:0xf
    v_add_f32 v20, v20, v22
    v_mov_b32_dpp v21, v40 quad_perm:[0,0,0,0] row_mask:0xf bank_mask:0xf
    v_mov_b32_dpp v22, v42 quad_perm:[2,2,2,2] row_mask:0xf bank_mask:0xf
    s_nop 0
    v_add_f32_dpp v21, v41, v21 quad_perm:[1,1,1,1] row_mask:0xf bank_mask:0xf
    v_add_f32_dpp v22, v43, v22 quad_perm:[3,3,3,3] row_mask:0xf bank_mask:0xf
    v_add_f32 v21, v21, v22
    v_cvt_pk_bf16_f32 v22, v20, v21
    v_lshlrev_b32 v20, 16, v22
    v_and_b32 v21, 0xffff0000, v22
    v_mul_f32 v20, 0x3db504f3, v20
    v_mul_f32 v21, 0x3db504f3, v21
    v_cvt_pk_bf16_f32 v22, v20, v21
    ds_write_b32 v250, v22
    v_add_u32 v250, 64, v250
    v_lshlrev_b32 v20, 16, v22
    v_and_b32 v21, 0xffff0000, v22
    v_max3_f32 v253, v20, v21, v253
    s_waitcnt vmcnt(16)
    v_lshlrev_b32 v152, 16, v216
    v_and_b32 v153, 0xffff0000, v216
    v_lshlrev_b32 v154, 16, v217
    v_and_b32 v155, 0xffff0000, v217
    v_lshlrev_b32 v156, 16, v218
    v_and_b32 v157, 0xffff0000, v218
    v_lshlrev_b32 v158, 16, v219
    v_and_b32 v159, 0xffff0000, v219
    v_lshlrev_b32 v160, 16, v220
    v_and_b32 v161, 0xffff0000, v220
    v_lshlrev_b32 v162, 16, v221
    v_and_b32 v163, 0xffff0000, v221
    v_lshlrev_b32 v164, 16, v222
    v_and_b32 v165, 0xffff0000, v222
    v_lshlrev_b32 v166, 16, v223
    v_and_b32 v167, 0xffff0000, v223
    v_lshlrev_b32 v168, 16, v224
    v_and_b32 v169, 0xffff0000, v224
    v_lshlrev_b32 v170, 16, v225
    v_and_b32 v171, 0xffff0000, v225
    v_lshlrev_b32 v172, 16, v226
    v_and_b32 v173, 0xffff0000, v226
    v_lshlrev_b32 v174, 16, v227
    v_and_b32 v175, 0xffff0000, v227
    v_lshlrev_b32 v176, 16, v228
    v_and_b32 v177, 0xffff0000, v228
    v_lshlrev_b32 v178, 16, v229
    v_and_b32 v179, 0xffff0000, v229
    v_lshlrev_b32 v180, 16, v230
    v_and_b32 v181, 0xffff0000, v230
    v_lshlrev_b32 v182, 16, v231
    v_and_b32 v183, 0xffff0000, v231
    v_and_b32 v20, 15, v0
    v_lshrrev_b32 v21, 4, v0
    v_lshlrev_b32 v184, 5, v20
    v_lshl_add_u32 v184, v21, 4, v184
    s_lshl_b32 s38, s3, 9
    v_add_u32 v184, s38, v184
    s_lshl_b32 s38, s3, 3
    v_mov_b32 v185, s38
    v_lshlrev_b32 v186, 3, v0
    v_lshlrev_b32 v187, 4, v0
    v_and_b32 v22, 7, v0
    v_lshrrev_b32 v23, 3, v0
    v_lshlrev_b32 v188, 10, v23
    v_lshl_add_u32 v188, v22, 4, v188
    v_lshlrev_b32 v189, 16, v23
    v_lshl_add_u32 v189, v22, 4, v189
    s_lshl_b32 s38, s3, 6
    v_add_u32 v191, s38, v186
    v_lshlrev_b32 v192, 2, v20
    v_lshlrev_b32 v193, 1, v0
    v_mov_b32 v194, 0
    v_mov_b32 v195, s40
    s_lshl_b32 s64, s2, 10
    s_add_u32 s64, s64, 524288
    s_lshl_b32 s65, s4, 13
    s_lshl_b32 s38, s5, 7
    s_add_u32 s65, s65, s38
    s_add_u32 s65, s65, 524288
    s_lshl_b32 s66, s3, 19
    s_lshl_b32 s38, s2, 7
    s_add_u32 s66, s66, s38
    s_add_u32 s66, s66, 1048576
    s_lshl_b32 s67, s4, 16
    s_lshl_b32 s38, s3, 13
    s_add_u32 s67, s67, s38
    s_add_u32 s67, s67, 1048576
    s_add_u32 s68, s67, 4096
    s_lshl_b32 s69, s4, 5
    s_and_b32 s38, s4, 7
    s_cmp_eq_u32 s38, s5
    s_cselect_b32 s58, 1, 0
    s_cmp_lg_u32 s7, 0
    s_cselect_b32 s61, s54, 16
    s_mov_b32 s57, 0
    s_lshl_b32 s38, s3, 2
    v_mov_b32 v245, s38
    s_mov_b32 s20, s70
    s_mov_b32 s21, s71
    s_mov_b32 s22, 1024
    s_mov_b32 s23, 0x20000
    s_mov_b32 s28, s52
    s_mov_b32 s29, s53
    s_mov_b32 s30, 1024
    s_mov_b32 s31, 0x20000
    s_cmp_eq_u32 s3, 1
    s_cselect_b32 s59, s58, 0
    s_lshl_b32 s60, s4, 16
    s_add_u32 s60, s60, 1081344
    v_mov_b32 v208, 0
    v_mov_b32 v210, 0
L_s0:
    s_cmp_eq_u32 s44, 1
    s_cbranch_scc1 L_V0
    s_cmp_eq_u32 s44, 2
    s_cbranch_scc1 L_M0
    s_cmp_lg_u32 s44, 0
    s_cbranch_scc1 L_X0
    s_waitcnt vmcnt(12)
    v_mfma_f32_16x16x32_bf16 v[12:15], v[56:59], v[24:27], 0
    v_mfma_f32_16x16x32_bf16 v[12:15], v[60:63], v[28:31], v[12:15]
    v_mfma_f32_16x16x32_bf16 v[12:15], v[64:67], v[32:35], v[12:15]
    v_mfma_f32_16x16x32_bf16 v[12:15], v[68:71], v[36:39], v[12:15]
    s_cmp_lg_u32 s36, 0
    s_cbranch_scc1 L_x19
    s_call_b64 s[88:89], L_switch
L_x19:
    s_lshr_b32 s34, s35, 1
    s_lshl_b32 s34, s34, 17
    s_xor_b32 s34, s34, s56
    s_lshr_b32 s39, s35, 5
    s_bitcmp1_b32 s7, s39
    s_cbranch_scc0 L_ph20m
    s_cmp_lt_u32 s35, 40
    s_cbranch_scc1 L_ph20m
    s_lshr_b32 s39, s6, s39
    s_xor_b32 s39, s39, s42
    s_and_b32 s39, s39, 1
    s_lshl_b32 s39, s39, 13
    s_xor_b32 s34, s34, s39
    s_xor_b32 s34, s34, s47
    s_bitcmp1_b32 s35, 0
    s_cselect_b32 s38, 32768, 0
    s_xor_b32 s34, s34, s38
    s_branch L_ph20e
L_ph20m:
    s_xor_b32 s34, s34, s26
    s_bitcmp1_b32 s35, 0
    s_cselect_b32 s38, 16384, 0
    s_xor_b32 s34, s34, s38
    s_bitcmp1_b32 s42, 0
    s_cselect_b32 s38, 32768, 0
    s_xor_b32 s34, s34, s38
L_ph20e:
    s_waitcnt vmcnt(6)
    buffer_load_dwordx4 v[56:59], v248, s[8:11], s34 offen nt
    s_xor_b32 s39, s34, 65536
    buffer_load_dwordx4 v[60:63], v248, s[8:11], s39 offen nt
    s_xor_b32 s38, s34, 1024
    buffer_load_dwordx4 v[64:67], v248, s[8:11], s38 offen nt
    s_xor_b32 s39, s34, 66560
    buffer_load_dwordx4 v[68:71], v248, s[8:11], s39 offen nt
    s_waitcnt vmcnt(12)
    v_mfma_f32_16x16x32_bf16 v[40:43], v[72:75], v[24:27], 0
    v_mfma_f32_16x16x32_bf16 v[40:43], v[76:79], v[28:31], v[40:43]
    v_mfma_f32_16x16x32_bf16 v[40:43], v[80:83], v[32:35], v[40:43]
    v_mfma_f32_16x16x32_bf16 v[40:43], v[84:87], v[36:39], v[40:43]
    s_waitcnt vmcnt(6)
    s_xor_b32 s34, s34, s55
    buffer_load_dwordx4 v[72:75], v249, s[12:15], s34 offen nt
    s_xor_b32 s39, s34, 65536
    buffer_load_dwordx4 v[76:79], v249, s[12:15], s39 offen nt
    s_xor_b32 s38, s34, 1024
    buffer_load_dwordx4 v[80:83], v249, s[12:15], s38 offen nt
    s_xor_b32 s39, s34, 66560
    buffer_load_dwordx4 v[84:87], v249, s[12:15], s39 offen nt
    s_add_u32 s35, s35, 1
    s_mov_b32 s44, s80
    s_and_b32 s80, s80, 3
    s_sub_u32 s36, s36, 1
    s_cmp_lg_u32 s36, s82
    s_cbranch_scc1 L_na21
    s_call_b64 s[90:91], L_claim
L_na21:
    s_cmp_lg_u32 s36, s83
    s_cbranch_scc1 L_na21p
    s_call_b64 s[90:91], L_publish
L_na21p:
    v_mov_b32_dpp v20, v12 quad_perm:[0,0,0,0] row_mask:0xf bank_mask:0xf
    v_mov_b32_dpp v22, v14 quad_perm:[2,2,2,2] row_mask:0xf bank_mask:0xf
    s_nop 0
    v_add_f32_dpp v20, v13, v20 quad_perm:[1,1,1,1] row_mask:0xf bank_mask:0xf
    v_add_f32_dpp v22, v15, v22 quad_perm:[3,3,3,3] row_mask:0xf bank_mask:0xf
    v_add_f32 v20, v20, v22
    v_mov_b32_dpp v21, v40 quad_perm:[0,0,0,0] row_mask:0xf bank_mask:0xf
    v_mov_b32_dpp v22, v42 quad_perm:[2,2,2,2] row_mask:0xf bank_mask:0xf
    s_nop 0
    v_add_f32_dpp v21, v41, v21 quad_perm:[1,1,1,1] row_mask:0xf bank_mask:0xf
    v_add_f32_dpp v22, v43, v22 quad_perm:[3,3,3,3] row_mask:0xf bank_mask:0xf
    v_add_f32 v21, v21, v22
    v_cvt_pk_bf16_f32 v22, v20, v21
    v_lshlrev_b32 v20, 16, v22
    v_and_b32 v21, 0xffff0000, v22
    v_mul_f32 v20, 0x3db504f3, v20
    v_mul_f32 v21, 0x3db504f3, v21
    v_cvt_pk_bf16_f32 v22, v20, v21
    ds_write_b32 v250, v22
    v_add_u32 v250, 64, v250
    v_lshlrev_b32 v20, 16, v22
    v_and_b32 v21, 0xffff0000, v22
    v_max3_f32 v253, v20, v21, v253
L_s1:
    s_cmp_eq_u32 s45, 1
    s_cbranch_scc1 L_V1
    s_cmp_eq_u32 s45, 2
    s_cbranch_scc1 L_M1
    s_cmp_lg_u32 s45, 0
    s_cbranch_scc1 L_X1
    s_waitcnt vmcnt(12)
    v_mfma_f32_16x16x32_bf16 v[12:15], v[88:91], v[24:27], 0
    v_mfma_f32_16x16x32_bf16 v[12:15], v[92:95], v[28:31], v[12:15]
    v_mfma_f32_16x16x32_bf16 v[12:15], v[96:99], v[32:35], v[12:15]
    v_mfma_f32_16x16x32_bf16 v[12:15], v[100:103], v[36:39], v[12:15]
    s_cmp_lg_u32 s36, 0
    s_cbranch_scc1 L_x22
    s_call_b64 s[88:89], L_switch
L_x22:
    s_lshr_b32 s34, s35, 1
    s_lshl_b32 s34, s34, 17
    s_xor_b32 s34, s34, s56
    s_lshr_b32 s39, s35, 5
    s_bitcmp1_b32 s7, s39
    s_cbranch_scc0 L_ph23m
    s_cmp_lt_u32 s35, 40
    s_cbranch_scc1 L_ph23m
    s_lshr_b32 s39, s6, s39
    s_xor_b32 s39, s39, s42
    s_and_b32 s39, s39, 1
    s_lshl_b32 s39, s39, 13
    s_xor_b32 s34, s34, s39
    s_xor_b32 s34, s34, s47
    s_bitcmp1_b32 s35, 0
    s_cselect_b32 s38, 32768, 0
    s_xor_b32 s34, s34, s38
    s_branch L_ph23e
L_ph23m:
    s_xor_b32 s34, s34, s26
    s_bitcmp1_b32 s35, 0
    s_cselect_b32 s38, 16384, 0
    s_xor_b32 s34, s34, s38
    s_bitcmp1_b32 s42, 0
    s_cselect_b32 s38, 32768, 0
    s_xor_b32 s34, s34, s38
L_ph23e:
    s_waitcnt vmcnt(6)
    buffer_load_dwordx4 v[88:91], v248, s[8:11], s34 offen nt
    s_xor_b32 s39, s34, 65536
    buffer_load_dwordx4 v[92:95], v248, s[8:11], s39 offen nt
    s_xor_b32 s38, s34, 1024
    buffer_load_dwordx4 v[96:99], v248, s[8:11], s38 offen nt
    s_xor_b32 s39, s34, 66560
    buffer_load_dwordx4 v[100:103], v248, s[8:11], s39 offen nt
    s_waitcnt vmcnt(12)
    v_mfma_f32_16x16x32_bf16 v[40:43], v[104:107], v[24:27], 0
    v_mfma_f32_16x16x32_bf16 v[40:43], v[108:111], v[28:31], v[40:43]
    v_mfma_f32_16x16x32_bf16 v[40:43], v[112:115], v[32:35], v[40:43]
    v_mfma_f32_16x16x32_bf16 v[40:43], v[116:119], v[36:39], v[40:43]
    s_waitcnt vmcnt(6)
    s_xor_b32 s34, s34, s55
    buffer_load_dwordx4 v[104:107], v249, s[12:15], s34 offen nt
    s_xor_b32 s39, s34, 65536
    buffer_load_dwordx4 v[108:111], v249, s[12:15], s39 offen nt
    s_xor_b32 s38, s34, 1024
    buffer_load_dwordx4 v[112:115], v249, s[12:15], s38 offen nt
    s_xor_b32 s39, s34, 66560
    buffer_load_dwordx4 v[116:119], v249, s[12:15], s39 offen nt
    s_add_u32 s35, s35, 1
    s_mov_b32 s45, s80
    s_and_b32 s80, s80, 3
    s_sub_u32 s36, s36, 1
    s_cmp_lg_u32 s36, s82
    s_cbranch_scc1 L_na24
    s_call_b64 s[90:91], L_claim
L_na24:
    s_cmp_lg_u32 s36, s83
    s_cbranch_scc1 L_na24p
    s_call_b64 s[90:91], L_publish
L_na24p:
    v_mov_b32_dpp v20, v12 quad_perm:[0,0,0,0] row_mask:0xf bank_mask:0xf
    v_mov_b32_dpp v22, v14 quad_perm:[2,2,2,2] row_mask:0xf bank_mask:0xf
    s_nop 0
    v_add_f32_dpp v20, v13, v20 quad_perm:[1,1,1,1] row_mask:0xf bank_mask:0xf
    v_add_f32_dpp v22, v15, v22 quad_perm:[3,3,3,3] row_mask:0xf bank_mask:0xf
    v_add_f32 v20, v20, v22
    v_mov_b32_dpp v21, v40 quad_perm:[0,0,0,0] row_mask:0xf bank_mask:0xf
    v_mov_b32_dpp v22, v42 quad_perm:[2,2,2,2] row_mask:0xf bank_mask:0xf
    s_nop 0
    v_add_f32_dpp v21, v41, v21 quad_perm:[1,1,1,1] row_mask:0xf bank_mask:0xf
    v_add_f32_dpp v22, v43, v22 quad_perm:[3,3,3,3] row_mask:0xf bank_mask:0xf
    v_add_f32 v21, v21, v22
    v_cvt_pk_bf16_f32 v22, v20, v21
    v_lshlrev_b32 v20, 16, v22
    v_and_b32 v21, 0xffff0000, v22
    v_mul_f32 v20, 0x3db504f3, v20
    v_mul_f32 v21, 0x3db504f3, v21
    v_cvt_pk_bf16_f32 v22, v20, v21
    ds_write_b32 v250, v22
    v_add_u32 v250, 64, v250
    v_lshlrev_b32 v20, 16, v22
    v_and_b32 v21, 0xffff0000, v22
    v_max3_f32 v253, v20, v21, v253
    s_branch L_s0
L_X0:
    s_cmp_eq_u32 s44, 3
    s_cbranch_scc1 L_done
    s_nop 1
    v_max_f32_dpp v253, v253, v253 row_ror:4 row_mask:0xf bank_mask:0xf
    s_nop 1
    v_max_f32_dpp v253, v253, v253 row_ror:8 row_mask:0xf bank_mask:0xf
    v_mov_b32 v23, v253
    s_nop 1
    v_permlane16_swap_b32 v253, v23
    s_nop 1
    v_max_f32 v253, v253, v23
    v_mov_b32 v23, v253
    s_nop 1
    v_permlane32_swap_b32 v253, v23
    s_nop 1
    v_max_f32 v253, v253, v23
    v_max_f32 v4, v4, v253
    v_mul_f32 v21, v4, v6
    v_sub_f32 v23, v5, v21
    v_exp_f32 v23, v23
    v_mov_b32 v5, v21
    v_and_b32 v250, 60, v0
    v_add_u32 v250, s27, v250
    v_mov_b32 v251, v250
    v_mul_f32 v3, v3, v23
    v_mul_f32 v8, v8, v23
    v_mul_f32 v9, v9, v23
    v_mul_f32 v10, v10, v23
    v_mul_f32 v11, v11, v23
L_V0:
    ds_read_b32 v20, v251
    v_add_u32 v251, 64, v251
    s_waitcnt lgkmcnt(0)
    v_lshlrev_b32 v21, 16, v20
    v_and_b32 v22, 0xffff0000, v20
    v_fma_f32 v21, v21, v6, -v5
    v_fma_f32 v22, v22, v6, -v5
    v_exp_f32 v21, v21
    v_exp_f32 v22, v22
    v_cvt_pk_bf16_f32 v20, v21, v21
    v_cvt_pk_bf16_f32 v23, v22, v22
    v_add_f32 v3, v3, v21
    v_add_f32 v3, v3, v22
    v_and_b32_dpp v40, v20, v16 row_newbcast:0 row_mask:0xf bank_mask:0xf
    v_and_b32_dpp v41, v20, v17 row_newbcast:0 row_mask:0xf bank_mask:0xf
    v_and_b32_dpp v42, v20, v18 row_newbcast:0 row_mask:0xf bank_mask:0xf
    v_and_b32_dpp v43, v20, v19 row_newbcast:0 row_mask:0xf bank_mask:0xf
    v_and_b32_dpp v44, v20, v16 row_newbcast:4 row_mask:0xf bank_mask:0xf
    v_and_b32_dpp v45, v20, v17 row_newbcast:4 row_mask:0xf bank_mask:0xf
    v_and_b32_dpp v46, v20, v18 row_newbcast:4 row_mask:0xf bank_mask:0xf
    v_and_b32_dpp v47, v20, v19 row_newbcast:4 row_mask:0xf bank_mask:0xf
    v_and_b32_dpp v48, v20, v16 row_newbcast:8 row_mask:0xf bank_mask:0xf
    v_and_b32_dpp v49, v20, v17 row_newbcast:8 row_mask:0xf bank_mask:0xf
    v_and_b32_dpp v50, v20, v18 row_newbcast:8 row_mask:0xf bank_mask:0xf
    v_and_b32_dpp v51, v20, v19 row_newbcast:8 row_mask:0xf bank_mask:0xf
    v_and_b32_dpp v52, v20, v16 row_newbcast:12 row_mask:0xf bank_mask:0xf
    v_and_b32_dpp v53, v20, v17 row_newbcast:12 row_mask:0xf bank_mask:0xf
    v_and_b32_dpp v54, v20, v18 row_newbcast:12 row_mask:0xf bank_mask:0xf
    v_and_b32_dpp v55, v20, v19 row_newbcast:12 row_mask:0xf bank_mask:0xf
    s_waitcnt vmcnt(12)
    v_mfma_f32_16x16x32_bf16 v[8:11], v[40:43], v[56:59], v[8:11]
    v_mfma_f32_16x16x32_bf16 v[8:11], v[44:47], v[60:63], v[8:11]
    v_mfma_f32_16x16x32_bf16 v[8:11], v[48:51], v[64:67], v[8:11]
    v_mfma_f32_16x16x32_bf16 v[8:11], v[52:55], v[68:71], v[8:11]
    s_cmp_lg_u32 s36, 0
    s_cbranch_scc1 L_x25
    s_call_b64 s[88:89], L_switch
L_x25:
    s_lshr_b32 s34, s35, 1
    s_lshl_b32 s34, s34, 17
    s_xor_b32 s34, s34, s56
    s_lshr_b32 s39, s35, 5
    s_bitcmp1_b32 s7, s39
    s_cbranch_scc0 L_ph26m
    s_cmp_lt_u32 s35, 40
    s_cbranch_scc1 L_ph26m
    s_lshr_b32 s39, s6, s39
    s_xor_b32 s39, s39, s42
    s_and_b32 s39, s39, 1
    s_lshl_b32 s39, s39, 13
    s_xor_b32 s34, s34, s39
    s_xor_b32 s34, s34, s47
    s_bitcmp1_b32 s35, 0
    s_cselect_b32 s38, 32768, 0
    s_xor_b32 s34, s34, s38
    s_branch L_ph26e
L_ph26m:
    s_xor_b32 s34, s34, s26
    s_bitcmp1_b32 s35, 0
    s_cselect_b32 s38, 16384, 0
    s_xor_b32 s34, s34, s38
    s_bitcmp1_b32 s42, 0
    s_cselect_b32 s38, 32768, 0
    s_xor_b32 s34, s34, s38
L_ph26e:
    s_waitcnt vmcnt(6)
    buffer_load_dwordx4 v[56:59], v248, s[8:11], s34 offen nt
    s_xor_b32 s39, s34, 65536
    buffer_load_dwordx4 v[60:63], v248, s[8:11], s39 offen nt
    s_xor_b32 s38, s34, 1024
    buffer_load_dwordx4 v[64:67], v248, s[8:11], s38 offen nt
    s_xor_b32 s39, s34, 66560
    buffer_load_dwordx4 v[68:71], v248, s[8:11], s39 offen nt
    v_and_b32_dpp v40, v23, v16 row_newbcast:0 row_mask:0xf bank_mask:0xf
    v_and_b32_dpp v41, v23, v17 row_newbcast:0 row_mask:0xf bank_mask:0xf
    v_and_b32_dpp v42, v23, v18 row_newbcast:0 row_mask:0xf bank_mask:0xf
    v_and_b32_dpp v43, v23, v19 row_newbcast:0 row_mask:0xf bank_mask:0xf
    v_and_b32_dpp v44, v23, v16 row_newbcast:4 row_mask:0xf bank_mask:0xf
    v_and_b32_dpp v45, v23, v17 row_newbcast:4 row_mask:0xf bank_mask:0xf
    v_and_b32_dpp v46, v23, v18 row_newbcast:4 row_mask:0xf bank_mask:0xf
    v_and_b32_dpp v47, v23, v19 row_newbcast:4 row_mask:0xf bank_mask:0xf
    v_and_b32_dpp v48, v23, v16 row_newbcast:8 row_mask:0xf bank_mask:0xf
    v_and_b32_dpp v49, v23, v17 row_newbcast:8 row_mask:0xf bank_mask:0xf
    v_and_b32_dpp v50, v23, v18 row_newbcast:8 row_mask:0xf bank_mask:0xf
    v_and_b32_dpp v51, v23, v19 row_newbcast:8 row_mask:0xf bank_mask:0xf
    v_and_b32_dpp v52, v23, v16 row_newbcast:12 row_mask:0xf bank_mask:0xf
    v_and_b32_dpp v53, v23, v17 row_newbcast:12 row_mask:0xf bank_mask:0xf
    v_and_b32_dpp v54, v23, v18 row_newbcast:12 row_mask:0xf bank_mask:0xf
    v_and_b32_dpp v55, v23, v19 row_newbcast:12 row_mask:0xf bank_mask:0xf
    s_waitcnt vmcnt(12)
    v_mfma_f32_16x16x32_bf16 v[8:11], v[40:43], v[72:75], v[8:11]
    v_mfma_f32_16x16x32_bf16 v[8:11], v[44:47], v[76:79], v[8:11]
    v_mfma_f32_16x16x32_bf16 v[8:11], v[48:51], v[80:83], v[8:11]
    v_mfma_f32_16x16x32_bf16 v[8:11], v[52:55], v[84:87], v[8:11]
    s_waitcnt vmcnt(6)
    s_xor_b32 s34, s34, s55
    buffer_load_dwordx4 v[72:75], v249, s[12:15], s34 offen nt
    s_xor_b32 s39, s34, 65536
    buffer_load_dwordx4 v[76:79], v249, s[12:15], s39 offen nt
    s_xor_b32 s38, s34, 1024
    buffer_load_dwordx4 v[80:83], v249, s[12:15], s38 offen nt
    s_xor_b32 s39, s34, 66560
    buffer_load_dwordx4 v[84:87], v249, s[12:15], s39 offen nt
    s_add_u32 s35, s35, 1
    s_mov_b32 s44, s80
    s_and_b32 s80, s80, 3
    s_sub_u32 s36, s36, 1
    s_cmp_lg_u32 s36, s82
    s_cbranch_scc1 L_na27
    s_call_b64 s[90:91], L_claim
L_na27:
    s_cmp_lg_u32 s36, s83
    s_cbranch_scc1 L_na27p
    s_call_b64 s[90:91], L_publish
L_na27p:
    s_branch L_s1
L_M0:
    s_waitcnt vmcnt(12)
    v_mfma_f32_16x16x32_bf16 v[12:15], v[56:59], v[24:27], 0
    v_mfma_f32_16x16x32_bf16 v[12:15], v[60:63], v[28:31], v[12:15]
    v_mfma_f32_16x16x32_bf16 v[12:15], v[64:67], v[32:35], v[12:15]
    v_mfma_f32_16x16x32_bf16 v[12:15], v[68:71], v[36:39], v[12:15]
    s_cmp_lg_u32 s36, 0
    s_cbranch_scc1 L_x28
    s_call_b64 s[88:89], L_switch
L_x28:
    s_lshr_b32 s34, s35, 1
    s_lshl_b32 s34, s34, 17
    s_xor_b32 s34, s34, s56
    s_lshr_b32 s39, s35, 5
    s_bitcmp1_b32 s7, s39
    s_cbranch_scc0 L_ph29m
    s_cmp_lt_u32 s35, 40
    s_cbranch_scc1 L_ph29m
    s_lshr_b32 s39, s6, s39
    s_xor_b32 s39, s39, s42
    s_and_b32 s39, s39, 1
    s_lshl_b32 s39, s39, 13
    s_xor_b32 s34, s34, s39
    s_xor_b32 s34, s34, s47
    s_bitcmp1_b32 s35, 0
    s_cselect_b32 s38, 32768, 0
    s_xor_b32 s34, s34, s38
    s_branch L_ph29e
L_ph29m:
    s_xor_b32 s34, s34, s26
    s_bitcmp1_b32 s35, 0
    s_cselect_b32 s38, 16384, 0
    s_xor_b32 s34, s34, s38
    s_bitcmp1_b32 s42, 0
    s_cselect_b32 s38, 32768, 0
    s_xor_b32 s34, s34, s38
L_ph29e:
    s_waitcnt vmcnt(6)
    buffer_load_dwordx4 v[56:59], v248, s[8:11], s34 offen nt
    s_xor_b32 s39, s34, 65536
    buffer_load_dwordx4 v[60:63], v248, s[8:11], s39 offen nt
    s_xor_b32 s38, s34, 1024
    buffer_load_dwordx4 v[64:67], v248, s[8:11], s38 offen nt
    s_xor_b32 s39, s34, 66560
    buffer_load_dwordx4 v[68:71], v248, s[8:11], s39 offen nt
    s_nop 1
    v_mov_b32_dpp v20, v12 quad_perm:[0,0,0,0] row_mask:0xf bank_mask:0xf
    v_mov_b32_dpp v21, v14 quad_perm:[2,2,2,2] row_mask:0xf bank_mask:0xf
    s_nop 0
    v_add_f32_dpp v20, v13, v20 quad_perm:[1,1,1,1] row_mask:0xf bank_mask:0xf
    v_add_f32_dpp v21, v15, v21 quad_perm:[3,3,3,3] row_mask:0xf bank_mask:0xf
    v_add_f32 v20, v20, v21
    v_cvt_pk_bf16_f32 v20, v20, v20
    v_and_b32 v20, 0xffff0000, v20
    v_mul_f32 v20, 0x3db504f3, v20
    v_cvt_pk_bf16_f32 v20, v20, v20
    v_and_b32 v20, 0xffff0000, v20
    v_cmp_gt_f32 vcc, v20, v4
    s_cbranch_vccnz L_r30_rare
L_r30_bk:
    v_fma_f32 v21, v20, v6, -v5
    v_exp_f32 v22, v21
    s_nop 0
    v_cvt_pk_bf16_f32 v23, v22, v22
    v_add_f32 v3, v3, v22
    s_nop 0
    v_and_b32_dpp v40, v23, v16 row_newbcast:0 row_mask:0xf bank_mask:0xf
    v_and_b32_dpp v41, v23, v17 row_newbcast:0 row_mask:0xf bank_mask:0xf
    v_and_b32_dpp v42, v23, v18 row_newbcast:0 row_mask:0xf bank_mask:0xf
    v_and_b32_dpp v43, v23, v19 row_newbcast:0 row_mask:0xf bank_mask:0xf
    v_and_b32_dpp v44, v23, v16 row_newbcast:4 row_mask:0xf bank_mask:0xf
    v_and_b32_dpp v45, v23, v17 row_newbcast:4 row_mask:0xf bank_mask:0xf
    v_and_b32_dpp v46, v23, v18 row_newbcast:4 row_mask:0xf bank_mask:0xf
    v_and_b32_dpp v47, v23, v19 row_newbcast:4 row_mask:0xf bank_mask:0xf
    v_and_b32_dpp v48, v23, v16 row_newbcast:8 row_mask:0xf bank_mask:0xf
    v_and_b32_dpp v49, v23, v17 row_newbcast:8 row_mask:0xf bank_mask:0xf
    v_and_b32_dpp v50, v23, v18 row_newbcast:8 row_mask:0xf bank_mask:0xf
    v_and_b32_dpp v51, v23, v19 row_newbcast:8 row_mask:0xf bank_mask:0xf
    v_and_b32_dpp v52, v23, v16 row_newbcast:12 row_mask:0xf bank_mask:0xf
    v_and_b32_dpp v53, v23, v17 row_newbcast:12 row_mask:0xf bank_mask:0xf
    v_and_b32_dpp v54, v23, v18 row_newbcast:12 row_mask:0xf bank_mask:0xf
    v_and_b32_dpp v55, v23, v19 row_newbcast:12 row_mask:0xf bank_mask:0xf
    s_waitcnt vmcnt(12)
    v_mfma_f32_16x16x32_bf16 v[8:11], v[40:43], v[72:75], v[8:11]
    v_mfma_f32_16x16x32_bf16 v[8:11], v[44:47], v[76:79], v[8:11]
    v_mfma_f32_16x16x32_bf16 v[8:11], v[48:51], v[80:83], v[8:11]
    v_mfma_f32_16x16x32_bf16 v[8:11], v[52:55], v[84:87], v[8:11]
    s_waitcnt vmcnt(6)
    s_xor_b32 s34, s34, s55
    buffer_load_dwordx4 v[72:75], v249, s[12:15], s34 offen nt
    s_xor_b32 s39, s34, 65536
    buffer_load_dwordx4 v[76:79], v249, s[12:15], s39 offen nt
    s_xor_b32 s38, s34, 1024
    buffer_load_dwordx4 v[80:83], v249, s[12:15], s38 offen nt
    s_xor_b32 s39, s34, 66560
    buffer_load_dwordx4 v[84:87], v249, s[12:15], s39 offen nt
    s_add_u32 s35, s35, 1
    s_mov_b32 s44, s80
    s_and_b32 s80, s80, 3
    s_sub_u32 s36, s36, 1
    s_cmp_lg_u32 s36, s82
    s_cbranch_scc1 L_na31
    s_call_b64 s[90:91], L_claim
L_na31:
    s_cmp_lg_u32 s36, s83
    s_cbranch_scc1 L_na31p
    s_call_b64 s[90:91], L_publish
L_na31p:
    s_branch L_s1
L_X1:
    s_cmp_eq_u32 s45, 3
    s_cbranch_scc1 L_done
    s_nop 1
    v_max_f32_dpp v253, v253, v253 row_ror:4 row_mask:0xf bank_mask:0xf
    s_nop 1
    v_max_f32_dpp v253, v253, v253 row_ror:8 row_mask:0xf bank_mask:0xf
    v_mov_b32 v23, v253
    s_nop 1
    v_permlane16_swap_b32 v253, v23
    s_nop 1
    v_max_f32 v253, v253, v23
    v_mov_b32 v23, v253
    s_nop 1
    v_permlane32_swap_b32 v253, v23
    s_nop 1
    v_max_f32 v253, v253, v23
    v_max_f32 v4, v4, v253
    v_mul_f32 v21, v4, v6
    v_sub_f32 v23, v5, v21
    v_exp_f32 v23, v23
    v_mov_b32 v5, v21
    v_and_b32 v250, 60, v0
    v_add_u32 v250, s27, v250
    v_mov_b32 v251, v250
    v_mul_f32 v3, v3, v23
    v_mul_f32 v8, v8, v23
    v_mul_f32 v9, v9, v23
    v_mul_f32 v10, v10, v23
    v_mul_f32 v11, v11, v23
L_V1:
    ds_read_b32 v20, v251
    v_add_u32 v251, 64, v251
    s_waitcnt lgkmcnt(0)
    v_lshlrev_b32 v21, 16, v20
    v_and_b32 v22, 0xffff0000, v20
    v_fma_f32 v21, v21, v6, -v5
    v_fma_f32 v22, v22, v6, -v5
    v_exp_f32 v21, v21
    v_exp_f32 v22, v22
    v_cvt_pk_bf16_f32 v20, v21, v21
    v_cvt_pk_bf16_f32 v23, v22, v22
    v_add_f32 v3, v3, v21
    v_add_f32 v3, v3, v22
    v_and_b32_dpp v40, v20, v16 row_newbcast:0 row_mask:0xf bank_mask:0xf
    v_and_b32_dpp v41, v20, v17 row_newbcast:0 row_mask:0xf bank_mask:0xf
    v_and_b32_dpp v42, v20, v18 row_newbcast:0 row_mask:0xf bank_mask:0xf
    v_and_b32_dpp v43, v20, v19 row_newbcast:0 row_mask:0xf bank_mask:0xf
    v_and_b32_dpp v44, v20, v16 row_newbcast:4 row_mask:0xf bank_mask:0xf
    v_and_b32_dpp v45, v20, v17 row_newbcast:4 row_mask:0xf bank_mask:0xf
    v_and_b32_dpp v46, v20, v18 row_newbcast:4 row_mask:0xf bank_mask:0xf
    v_and_b32_dpp v47, v20, v19 row_newbcast:4 row_mask:0xf bank_mask:0xf
    v_and_b32_dpp v48, v20, v16 row_newbcast:8 row_mask:0xf bank_mask:0xf
    v_and_b32_dpp v49, v20, v17 row_newbcast:8 row_mask:0xf bank_mask:0xf
    v_and_b32_dpp v50, v20, v18 row_newbcast:8 row_mask:0xf bank_mask:0xf
    v_and_b32_dpp v51, v20, v19 row_newbcast:8 row_mask:0xf bank_mask:0xf
    v_and_b32_dpp v52, v20, v16 row_newbcast:12 row_mask:0xf bank_mask:0xf
    v_and_b32_dpp v53, v20, v17 row_newbcast:12 row_mask:0xf bank_mask:0xf
    v_and_b32_dpp v54, v20, v18 row_newbcast:12 row_mask:0xf bank_mask:0xf
    v_and_b32_dpp v55, v20, v19 row_newbcast:12 row_mask:0xf bank_mask:0xf
    s_waitcnt vmcnt(12)
    v_mfma_f32_16x16x32_bf16 v[8:11], v[40:43], v[88:91], v[8:11]
    v_mfma_f32_16x16x32_bf16 v[8:11], v[44:47], v[92:95], v[8:11]
    v_mfma_f32_16x16x32_bf16 v[8:11], v[48:51], v[96:99], v[8:11]
    v_mfma_f32_16x16x32_bf16 v[8:11], v[52:55], v[100:103], v[8:11]
    s_cmp_lg_u32 s36, 0
    s_cbranch_scc1 L_x32
    s_call_b64 s[88:89], L_switch
L_x32:
    s_lshr_b32 s34, s35, 1
    s_lshl_b32 s34, s34, 17
    s_xor_b32 s34, s34, s56
    s_lshr_b32 s39, s35, 5
    s_bitcmp1_b32 s7, s39
    s_cbranch_scc0 L_ph33m
    s_cmp_lt_u32 s35, 40
    s_cbranch_scc1 L_ph33m
    s_lshr_b32 s39, s6, s39
    s_xor_b32 s39, s39, s42
    s_and_b32 s39, s39, 1
    s_lshl_b32 s39, s39, 13
    s_xor_b32 s34, s34, s39
    s_xor_b32 s34, s34, s47
    s_bitcmp1_b32 s35, 0
    s_cselect_b32 s38, 32768, 0
    s_xor_b32 s34, s34, s38
    s_branch L_ph33e
L_ph33m:
    s_xor_b32 s34, s34, s26
    s_bitcmp1_b32 s35, 0
    s_cselect_b32 s38, 16384, 0
    s_xor_b32 s34, s34, s38
    s_bitcmp1_b32 s42, 0
    s_cselect_b32 s38, 32768, 0
    s_xor_b32 s34, s34, s38
L_ph33e:
    s_waitcnt vmcnt(6)
    buffer_load_dwordx4 v[88:91], v248, s[8:11], s34 offen nt
    s_xor_b32 s39, s34, 65536
    buffer_load_dwordx4 v[92:95], v248, s[8:11], s39 offen nt
    s_xor_b32 s38, s34, 1024
    buffer_load_dwordx4 v[96:99], v248, s[8:11], s38 offen nt
    s_xor_b32 s39, s34, 66560
    buffer_load_dwordx4 v[100:103], v248, s[8:11], s39 offen nt
    v_and_b32_dpp v40, v23, v16 row_newbcast:0 row_mask:0xf bank_mask:0xf
    v_and_b32_dpp v41, v23, v17 row_newbcast:0 row_mask:0xf bank_mask:0xf
    v_and_b32_dpp v42, v23, v18 row_newbcast:0 row_mask:0xf bank_mask:0xf
    v_and_b32_dpp v43, v23, v19 row_newbcast:0 row_mask:0xf bank_mask:0xf
    v_and_b32_dpp v44, v23, v16 row_newbcast:4 row_mask:0xf bank_mask:0xf
    v_and_b32_dpp v45, v23, v17 row_newbcast:4 row_mask:0xf bank_mask:0xf
    v_and_b32_dpp v46, v23, v18 row_newbcast:4 row_mask:0xf bank_mask:0xf
    v_and_b32_dpp v47, v23, v19 row_newbcast:4 row_mask:0xf bank_mask:0xf
    v_and_b32_dpp v48, v23, v16 row_newbcast:8 row_mask:0xf bank_mask:0xf
    v_and_b32_dpp v49, v23, v17 row_newbcast:8 row_mask:0xf bank_mask:0xf
    v_and_b32_dpp v50, v23, v18 row_newbcast:8 row_mask:0xf bank_mask:0xf
    v_and_b32_dpp v51, v23, v19 row_newbcast:8 row_mask:0xf bank_mask:0xf
    v_and_b32_dpp v52, v23, v16 row_newbcast:12 row_mask:0xf bank_mask:0xf
    v_and_b32_dpp v53, v23, v17 row_newbcast:12 row_mask:0xf bank_mask:0xf
    v_and_b32_dpp v54, v23, v18 row_newbcast:12 row_mask:0xf bank_mask:0xf
    v_and_b32_dpp v55, v23, v19 row_newbcast:12 row_mask:0xf bank_mask:0xf
    s_waitcnt vmcnt(12)
    v_mfma_f32_16x16x32_bf16 v[8:11], v[40:43], v[104:107], v[8:11]
    v_mfma_f32_16x16x32_bf16 v[8:11], v[44:47], v[108:111], v[8:11]
    v_mfma_f32_16x16x32_bf16 v[8:11], v[48:51], v[112:115], v[8:11]
    v_mfma_f32_16x16x32_bf16 v[8:11], v[52:55], v[116:119], v[8:11]
    s_waitcnt vmcnt(6)
    s_xor_b32 s34, s34, s55
    buffer_load_dwordx4 v[104:107], v249, s[12:15], s34 offen nt
    s_xor_b32 s39, s34, 65536
    buffer_load_dwordx4 v[108:111], v249, s[12:15], s39 offen nt
    s_xor_b32 s38, s34, 1024
    buffer_load_dwordx4 v[112:115], v249, s[12:15], s38 offen nt
    s_xor_b32 s39, s34, 66560
    buffer_load_dwordx4 v[116:119], v249, s[12:15], s39 offen nt
    s_add_u32 s35, s35, 1
    s_mov_b32 s45, s80
    s_and_b32 s80, s80, 3
    s_sub_u32 s36, s36, 1
    s_cmp_lg_u32 s36, s82
    s_cbranch_scc1 L_na34
    s_call_b64 s[90:91], L_claim
L_na34:
    s_cmp_lg_u32 s36, s83
    s_cbranch_scc1 L_na34p
    s_call_b64 s[90:91], L_publish
L_na34p:
    s_branch L_s0
L_M1:
    s_waitcnt vmcnt(12)
    v_mfma_f32_16x16x32_bf16 v[12:15], v[88:91], v[24:27], 0
    v_mfma_f32_16x16x32_bf16 v[12:15], v[92:95], v[28:31], v[12:15]
    v_mfma_f32_16x16x32_bf16 v[12:15], v[96:99], v[32:35], v[12:15]
    v_mfma_f32_16x16x32_bf16 v[12:15], v[100:103], v[36:39], v[12:15]
    s_cmp_lg_u32 s36, 0
    s_cbranch_scc1 L_x35
    s_call_b64 s[88:89], L_switch
L_x35:
    s_lshr_b32 s34, s35, 1
    s_lshl_b32 s34, s34, 17
    s_xor_b32 s34, s34, s56
    s_lshr_b32 s39, s35, 5
    s_bitcmp1_b32 s7, s39
    s_cbranch_scc0 L_ph36m
    s_cmp_lt_u32 s35, 40
    s_cbranch_scc1 L_ph36m
    s_lshr_b32 s39, s6, s39
    s_xor_b32 s39, s39, s42
    s_and_b32 s39, s39, 1
    s_lshl_b32 s39, s39, 13
    s_xor_b32 s34, s34, s39
    s_xor_b32 s34, s34, s47
    s_bitcmp1_b32 s35, 0
    s_cselect_b32 s38, 32768, 0
    s_xor_b32 s34, s34, s38
    s_branch L_ph36e
L_ph36m:
    s_xor_b32 s34, s34, s26
    s_bitcmp1_b32 s35, 0
    s_cselect_b32 s38, 16384, 0
    s_xor_b32 s34, s34, s38
    s_bitcmp1_b32 s42, 0
    s_cselect_b32 s38, 32768, 0
    s_xor_b32 s34, s34, s38
L_ph36e:
    s_waitcnt vmcnt(6)
    buffer_load_dwordx4 v[88:91], v248, s[8:11], s34 offen nt
    s_xor_b32 s39, s34, 65536
    buffer_load_dwordx4 v[92:95], v248, s[8:11], s39 offen nt
    s_xor_b32 s38, s34, 1024
    buffer_load_dwordx4 v[96:99], v248, s[8:11], s38 offen nt
    s_xor_b32 s39, s34, 66560
    buffer_load_dwordx4 v[100:103], v248, s[8:11], s39 offen nt
    s_nop 1
    v_mov_b32_dpp v20, v12 quad_perm:[0,0,0,0] row_mask:0xf bank_mask:0xf
    v_mov_b32_dpp v21, v14 quad_perm:[2,2,2,2] row_mask:0xf bank_mask:0xf
    s_nop 0
    v_add_f32_dpp v20, v13, v20 quad_perm:[1,1,1,1] row_mask:0xf bank_mask:0xf
    v_add_f32_dpp v21, v15, v21 quad_perm:[3,3,3,3] row_mask:0xf bank_mask:0xf
    v_add_f32 v20, v20, v21
    v_cvt_pk_bf16_f32 v20, v20, v20
    v_and_b32 v20, 0xffff0000, v20
    v_mul_f32 v20, 0x3db504f3, v20
    v_cvt_pk_bf16_f32 v20, v20, v20
    v_and_b32 v20, 0xffff0000, v20
    v_cmp_gt_f32 vcc, v20, v4
    s_cbranch_vccnz L_r37_rare
L_r37_bk:
    v_fma_f32 v21, v20, v6, -v5
    v_exp_f32 v22, v21
    s_nop 0
    v_cvt_pk_bf16_f32 v23, v22, v22
    v_add_f32 v3, v3, v22
    s_nop 0
    v_and_b32_dpp v40, v23, v16 row_newbcast:0 row_mask:0xf bank_mask:0xf
    v_and_b32_dpp v41, v23, v17 row_newbcast:0 row_mask:0xf bank_mask:0xf
    v_and_b32_dpp v42, v23, v18 row_newbcast:0 row_mask:0xf bank_mask:0xf
    v_and_b32_dpp v43, v23, v19 row_newbcast:0 row_mask:0xf bank_mask:0xf
    v_and_b32_dpp v44, v23, v16 row_newbcast:4 row_mask:0xf bank_mask:0xf
    v_and_b32_dpp v45, v23, v17 row_newbcast:4 row_mask:0xf bank_mask:0xf
    v_and_b32_dpp v46, v23, v18 row_newbcast:4 row_mask:0xf bank_mask:0xf
    v_and_b32_dpp v47, v23, v19 row_newbcast:4 row_mask:0xf bank_mask:0xf
    v_and_b32_dpp v48, v23, v16 row_newbcast:8 row_mask:0xf bank_mask:0xf
    v_and_b32_dpp v49, v23, v17 row_newbcast:8 row_mask:0xf bank_mask:0xf
    v_and_b32_dpp v50, v23, v18 row_newbcast:8 row_mask:0xf bank_mask:0xf
    v_and_b32_dpp v51, v23, v19 row_newbcast:8 row_mask:0xf bank_mask:0xf
    v_and_b32_dpp v52, v23, v16 row_newbcast:12 row_mask:0xf bank_mask:0xf
    v_and_b32_dpp v53, v23, v17 row_newbcast:12 row_mask:0xf bank_mask:0xf
    v_and_b32_dpp v54, v23, v18 row_newbcast:12 row_mask:0xf bank_mask:0xf
    v_and_b32_dpp v55, v23, v19 row_newbcast:12 row_mask:0xf bank_mask:0xf
    s_waitcnt vmcnt(12)
    v_mfma_f32_16x16x32_bf16 v[8:11], v[40:43], v[104:107], v[8:11]
    v_mfma_f32_16x16x32_bf16 v[8:11], v[44:47], v[108:111], v[8:11]
    v_mfma_f32_16x16x32_bf16 v[8:11], v[48:51], v[112:115], v[8:11]
    v_mfma_f32_16x16x32_bf16 v[8:11], v[52:55], v[116:119], v[8:11]
    s_waitcnt vmcnt(6)
    s_xor_b32 s34, s34, s55
    buffer_load_dwordx4 v[104:107], v249, s[12:15], s34 offen nt
    s_xor_b32 s39, s34, 65536
    buffer_load_dwordx4 v[108:111], v249, s[12:15], s39 offen nt
    s_xor_b32 s38, s34, 1024
    buffer_load_dwordx4 v[112:115], v249, s[12:15], s38 offen nt
    s_xor_b32 s39, s34, 66560
    buffer_load_dwordx4 v[116:119], v249, s[12:15], s39 offen nt
    s_add_u32 s35, s35, 1
    s_mov_b32 s45, s80
    s_and_b32 s80, s80, 3
    s_sub_u32 s36, s36, 1
    s_cmp_lg_u32 s36, s82
    s_cbranch_scc1 L_na38
    s_call_b64 s[90:91], L_claim
L_na38:
    s_cmp_lg_u32 s36, s83
    s_cbranch_scc1 L_na38p
    s_call_b64 s[90:91], L_publish
L_na38p:
    s_branch L_s0
L_claim:
    v_mov_b32 v7, 1
    s_mov_b64 exec, 1
    ds_add_rtn_u32 v7, v254, v7 offset:8
    s_mov_b64 exec, -1
    s_waitcnt lgkmcnt(0)
    v_readfirstlane_b32 s38, v7
    s_nop 0
    s_cmp_lg_u32 s38, 0
    s_cbranch_scc1 L_claim_r
    s_mov_b32 s83, 0
    s_lshl_b32 s37, 1, s54
    s_atomic_add s37, s[32:33], 0 glc
L_claim_r:
    s_setpc_b64 s[90:91]
L_publish:
    s_waitcnt lgkmcnt(0)
    s_or_b32 s38, s37, 0x80000000
    v_mov_b32 v7, s38
    s_mov_b32 s83, -1
    ds_write_b32 v254, v7 offset:12
    s_setpc_b64 s[90:91]
L_switch:
    s_cmp_eq_u32 s81, 1
    s_cbranch_scc1 L_swV
    s_mov_b32 s41, 6400000
L_need:
    ds_read_b32 v7, v254 offset:12
    ds_read_b32 v255, v254 offset:8
    s_sub_u32 s41, s41, 1
    s_waitcnt lgkmcnt(0)
    v_readfirstlane_b32 s37, v7
    v_readfirstlane_b32 s38, v255
    s_cmp_eq_u32 s41, 0
    s_cbranch_scc1 L_needx
    s_cmp_eq_u32 s37, 0
    s_cbranch_scc1 L_need
    s_cmp_lt_u32 s38, 4
    s_cbranch_scc1 L_need
L_needx:
    v_add_u32 v254, 8, v254
    s_xor_b32 s39, s54, 16
    s_lshr_b32 s38, s37, s39
    s_and_b32 s38, s38, 0x7fff
    s_lshr_b32 s37, s37, s54
    s_and_b32 s37, s37, 0x7fff
    s_cmp_eq_u32 s41, 0
    s_cselect_b32 s37, 0x7fff, s37
    s_cselect_b32 s38, 0x7fff, s38
    s_lshl_b32 s63, s54, 7
    s_cmp_lg_u32 s7, 0
    s_cbranch_scc1 L_twoq
    s_and_b32 s63, s37, 1
    s_lshl_b32 s63, s63, 11
    s_lshr_b32 s37, s37, 1
L_twoq:
    s_cmp_lt_u32 s37, 40
    s_cbranch_scc1 L_decK
    s_cmp_lt_u32 s37, 48
    s_cbranch_scc1 L_decM
    s_mov_b32 s25, 101
    s_cmp_ge_u32 s38, 48
    s_cbranch_scc1 L_dec
    s_cmp_lg_u32 s54, s61
    s_cbranch_scc1 L_dec
    s_mov_b32 s54, s39
    s_call_b64 s[90:91], L_claim
    s_cmp_lg_u32 s83, 0
    s_cbranch_scc1 L_need
    s_call_b64 s[90:91], L_publish
    s_branch L_need
L_decM:
    s_mov_b32 s25, 100
    s_sub_u32 s38, s37, 40
    s_and_b32 s24, s38, 1
    s_lshr_b32 s38, s38, 1
    s_add_u32 s38, s38, 252
    s_lshl_b32 s38, s38, 12
    s_or_b32 s24, s24, s38
    s_or_b32 s24, s24, s63
    s_branch L_dec
L_decK:
    s_mov_b32 s24, 20
    s_mov_b32 s38, 40
    s_mov_b32 s39, 0
    s_mov_b32 s25, 0
    s_cmp_ge_u32 s37, 4
    s_cselect_b32 s24, 12, s24
    s_cselect_b32 s38, 120, s38
    s_cselect_b32 s39, 4, s39
    s_cmp_ge_u32 s37, 8
    s_cselect_b32 s24, 6, s24
    s_cselect_b32 s38, 168, s38
    s_cselect_b32 s39, 8, s39
    s_cmp_ge_u32 s37, 12
    s_cselect_b32 s24, 4, s24
    s_cselect_b32 s38, 192, s38
    s_cselect_b32 s39, 12, s39
    s_cmp_ge_u32 s37, 16
    s_cselect_b32 s24, 2, s24
    s_cselect_b32 s38, 208, s38
    s_cselect_b32 s39, 16, s39
    s_cmp_ge_u32 s37, 20
    s_cselect_b32 s24, 3, s24
    s_cselect_b32 s38, 216, s38
    s_cselect_b32 s39, 20, s39
    s_cselect_b32 s25, 50, s25
    s_cmp_ge_u32 s37, 24
    s_cselect_b32 s24, 2, s24
    s_cselect_b32 s38, 228, s38
    s_cselect_b32 s39, 24, s39
    s_cmp_ge_u32 s37, 32
    s_cselect_b32 s24, 1, s24
    s_cselect_b32 s38, 244, s38
    s_cselect_b32 s39, 32, s39
    s_sub_u32 s39, s37, s39
    s_mul_i32 s39, s39, s24
    s_add_u32 s38, s38, s39
    s_lshl_b32 s38, s38, 12
    s_add_u32 s39, s86, s24
    s_or_b32 s24, s24, s38
    s_or_b32 s24, s24, s63
    s_cmp_eq_u32 s81, 2
    s_cbranch_scc1 L_endV
    s_cmp_gt_u32 s39, 128
    s_cbranch_scc1 L_toV
    s_cmp_ge_u32 s84, 64
    s_cbranch_scc1 L_toV
    s_cmp_eq_u32 s25, s87
    s_cbranch_scc1 L_startK
L_dec:
    s_cmp_eq_u32 s81, 2
    s_cbranch_scc1 L_take
L_toV:
    s_mov_b32 s81, 1
    s_mov_b32 s80, 5
    s_mov_b32 s85, 0
    s_mov_b32 s82, -1
    s_mov_b32 s8, s78
    s_mov_b32 s9, s79
    s_mov_b32 s12, s78
    s_mov_b32 s13, s79
    v_mov_b32 v248, v2
    v_mov_b32 v249, v2
L_swV:
    s_cmp_eq_u32 s85, s84
    s_cbranch_scc1 L_endV
    v_readlane_b32 s38, v252, s85
    s_add_u32 s85, s85, 1
    s_nop 0
    s_and_b32 s36, s38, 0x7ff
    s_bfe_u32 s42, s38, 0x1000b
    s_lshr_b32 s35, s38, 12
    s_setpc_b64 s[88:89]
L_endV:
    s_mov_b32 s8, s76
    s_mov_b32 s9, s77
    v_mov_b32 v248, v1
    s_cmp_ge_u32 s25, 100
    s_cbranch_scc1 L_toM
    s_mov_b32 s81, 0
    s_mov_b32 s80, 0
    s_mov_b32 s84, 0
    s_mov_b32 s86, 0
    s_cmp_eq_u32 s25, 50
    s_cselect_b32 s87, 51, s25
    s_mov_b32 s12, s76
    s_mov_b32 s13, s77
    v_mov_b32 v249, v1
    s_mov_b32 s56, 0
    s_mov_b32 s55, 2048
L_startK:
    s_mov_b32 m0, s84
    s_and_b32 s36, s24, 0x7ff
    s_bfe_u32 s42, s24, 0x1000b
    v_writelane_b32 v252, s24, m0
    s_lshr_b32 s35, s24, 12
    s_add_u32 s86, s86, s36
    s_add_u32 s84, s84, 1
    s_branch L_arm
L_toM:
    s_mov_b32 s81, 2
    s_mov_b32 s80, 2
    s_mov_b32 s12, s78
    s_mov_b32 s13, s79
L_take:
    s_cmp_eq_u32 s25, 100
    s_cbranch_scc1 L_takeM
    s_mov_b32 s35, 256
    s_mov_b32 s36, 0x100000
    s_mov_b32 s80, 3
    s_mov_b32 s82, -1
    s_cmp_lg_u32 s59, 1
    s_cbranch_scc1 L_ret
    buffer_load_ushort v212, v193, s[28:31], s69 offen
    buffer_load_dwordx4 v[196:199], v187, s[16:19], s60 offen sc1
    buffer_load_dwordx4 v[200:203], v187, s[16:19], s60 offen offset:1024 sc1
    buffer_load_dwordx4 v[204:207], v187, s[16:19], s60 offen offset:2048 sc1
    s_mov_b32 exec_hi, 0
    buffer_load_dwordx4 v[208:211], v187, s[16:19], s60 offen offset:3072 sc1
    s_mov_b64 exec, -1
    s_setpc_b64 s[88:89]
L_takeM:
    s_lshr_b32 s35, s24, 12
    s_bfe_u32 s42, s24, 0x1000b
    s_bitcmp1_b32 s24, 0
    s_cselect_b32 s56, 2048, 0
    s_mov_b32 s55, 0
    s_mov_b32 s36, 1
L_arm:
    s_mov_b32 s82, 0
    s_cmp_gt_u32 s36, 0
    s_cbranch_scc1 L_ret
    s_call_b64 s[90:91], L_claim
L_ret:
    s_setpc_b64 s[88:89]
L_r30_rare:
    v_mov_b32 v21, v20
    s_nop 1
    v_max_f32_dpp v21, v21, v21 row_ror:4 row_mask:0xf bank_mask:0xf
    s_nop 1
    v_max_f32_dpp v21, v21, v21 row_ror:8 row_mask:0xf bank_mask:0xf
    v_mov_b32 v23, v21
    s_nop 1
    v_permlane16_swap_b32 v21, v23
    s_nop 1
    v_max_f32 v21, v21, v23
    v_mov_b32 v23, v21
    s_nop 1
    v_permlane32_swap_b32 v21, v23
    s_nop 1
    v_max_f32 v21, v21, v23
    v_max_f32 v4, v4, v21
    v_mul_f32 v21, v4, v6
    v_sub_f32 v23, v5, v21
    v_exp_f32 v23, v23
    v_mov_b32 v5, v21
    v_mul_f32 v3, v3, v23
    v_mul_f32 v8, v8, v23
    v_mul_f32 v9, v9, v23
    v_mul_f32 v10, v10, v23
    v_mul_f32 v11, v11, v23
    s_branch L_r30_bk
L_r37_rare:
    v_mov_b32 v21, v20
    s_nop 1
    v_max_f32_dpp v21, v21, v21 row_ror:4 row_mask:0xf bank_mask:0xf
    s_nop 1
    v_max_f32_dpp v21, v21, v21 row_ror:8 row_mask:0xf bank_mask:0xf
    v_mov_b32 v23, v21
    s_nop 1
    v_permlane16_swap_b32 v21, v23
    s_nop 1
    v_max_f32 v21, v21, v23
    v_mov_b32 v23, v21
    s_nop 1
    v_permlane32_swap_b32 v21, v23
    s_nop 1
    v_max_f32 v21, v21, v23
    v_max_f32 v4, v4, v21
    v_mul_f32 v21, v4, v6
    v_sub_f32 v23, v5, v21
    v_exp_f32 v23, v23
    v_mov_b32 v5, v21
    v_mul_f32 v3, v3, v23
    v_mul_f32 v8, v8, v23
    v_mul_f32 v9, v9, v23
    v_mul_f32 v10, v10, v23
    v_mul_f32 v11, v11, v23
    s_branch L_r37_bk
L_done:
    s_mov_b32 exec_hi, 0
    ds_write_b128 v184, v[8:11] offset:2048
    s_mov_b64 exec, -1
    s_nop 1
    v_add_f32_dpp v3, v3, v3 row_ror:4 row_mask:0xf bank_mask:0xf
    s_nop 1
    v_add_f32_dpp v3, v3, v3 row_ror:8 row_mask:0xf bank_mask:0xf
    v_mov_b32 v21, v3
    s_nop 1
    v_permlane16_swap_b32 v3, v21
    s_nop 1
    v_add_f32 v3, v3, v21
    v_mov_b32 v21, v3
    s_nop 1
    v_permlane32_swap_b32 v3, v21
    s_nop 1
    v_add_f32 v3, v3, v21
    v_mov_b32 v6, v5
    v_mov_b32 v7, v3
    ds_write_b64 v185, v[6:7] offset:4096
    s_waitcnt lgkmcnt(0)
    s_barrier
    s_cmp_lg_u32 s3, 0
    s_cbranch_scc1 L_notw0
    ds_read_b128 v[24:27], v194 offset:4096
    ds_read_b128 v[28:31], v194 offset:4112
    ds_read_b64 v[32:33], v186 offset:2048
    ds_read_b64 v[34:35], v186 offset:2560
    ds_read_b64 v[36:37], v186 offset:3072
    ds_read_b64 v[38:39], v186 offset:3584
    v_mov_b32 v15, v195
    s_waitcnt lgkmcnt(4)
    v_max_f32 v8, v24, v26
    v_max3_f32 v8, v28, v30, v8
    v_sub_f32 v24, v24, v8
    v_sub_f32 v26, v26, v8
    v_sub_f32 v28, v28, v8
    v_sub_f32 v30, v30, v8
    v_exp_f32 v24, v24
    v_exp_f32 v26, v26
    v_exp_f32 v28, v28
    v_exp_f32 v30, v30
    v_mul_f32 v10, v24, v25
    v_fmac_f32 v10, v26, v27
    v_fmac_f32 v10, v28, v29
    v_fmac_f32 v10, v30, v31
    v_log_f32 v14, v10
    v_rcp_f32 v10, v10
    s_waitcnt lgkmcnt(0)
    v_mul_f32 v12, v24, v32
    v_mul_f32 v13, v24, v33
    v_fmac_f32 v12, v26, v34
    v_fmac_f32 v13, v26, v35
    v_fmac_f32 v12, v28, v36
    v_fmac_f32 v13, v28, v37
    v_fmac_f32 v12, v30, v38
    v_fmac_f32 v13, v30, v39
    v_add_f32 v14, v14, v8
    v_mul_f32 v12, v12, v10
    v_mul_f32 v13, v13, v10
    buffer_store_dwordx4 v[12:15], v187, s[16:19], s64 offen sc1
L_h1wait:
    s_barrier
    ds_read_b128 v[24:27], v194 offset:5888
    ds_read_b128 v[28:31], v194 offset:5904
    ds_read_b128 v[32:35], v194 offset:5920
    ds_read_b128 v[36:39], v194 offset:5936
    v_mov_b32 v9, v195
    v_mov_b32 v11, v195
    s_waitcnt lgkmcnt(3)
    v_mul_f32 v8, v24, v152
    v_mul_f32 v10, v24, v153
    v_fmac_f32 v8, v25, v154
    v_fmac_f32 v10, v25, v155
    v_fmac_f32 v8, v26, v156
    v_fmac_f32 v10, v26, v157
    v_fmac_f32 v8, v27, v158
    v_fmac_f32 v10, v27, v159
    s_waitcnt lgkmcnt(2)
    v_fmac_f32 v8, v28, v160
    v_fmac_f32 v10, v28, v161
    v_fmac_f32 v8, v29, v162
    v_fmac_f32 v10, v29, v163
    v_fmac_f32 v8, v30, v164
    v_fmac_f32 v10, v30, v165
    v_fmac_f32 v8, v31, v166
    v_fmac_f32 v10, v31, v167
    s_waitcnt lgkmcnt(1)
    v_fmac_f32 v8, v32, v168
    v_fmac_f32 v10, v32, v169
    v_fmac_f32 v8, v33, v170
    v_fmac_f32 v10, v33, v171
    v_fmac_f32 v8, v34, v172
    v_fmac_f32 v10, v34, v173
    v_fmac_f32 v8, v35, v174
    v_fmac_f32 v10, v35, v175
    s_waitcnt lgkmcnt(0)
    v_fmac_f32 v8, v36, v176
    v_fmac_f32 v10, v36, v177
    v_fmac_f32 v8, v37, v178
    v_fmac_f32 v10, v37, v179
    v_fmac_f32 v8, v38, v180
    v_fmac_f32 v10, v38, v181
    v_fmac_f32 v8, v39, v182
    v_fmac_f32 v10, v39, v183
    buffer_store_dwordx4 v[8:11], v189, s[16:19], s66 offen sc1
    s_cmp_eq_u32 s58, 0
    s_cbranch_scc1 L_end
    s_mov_b64 s[76:77], -1
    s_mov_b64 s[78:79], -1
    s_mov_b64 s[80:81], -1
    s_mov_b64 s[82:83], -1
    s_mov_b64 s[84:85], -1
    s_mov_b64 s[86:87], -1
    s_mov_b64 s[88:89], -1
    s_mov_b64 s[90:91], -1
    s_mov_b32 s41, 400000
L_h2_loop:
    s_mov_b64 exec, s[76:77]
    s_cbranch_execz L_h2_s0
    buffer_load_dwordx4 v[24:27], v187, s[16:19], s67 offen offset:0 sc1
L_h2_s0:
    s_mov_b64 exec, s[78:79]
    s_cbranch_execz L_h2_s1
    buffer_load_dwordx4 v[28:31], v187, s[16:19], s67 offen offset:1024 sc1
L_h2_s1:
    s_mov_b64 exec, s[80:81]
    s_cbranch_execz L_h2_s2
    buffer_load_dwordx4 v[32:35], v187, s[16:19], s67 offen offset:2048 sc1
L_h2_s2:
    s_mov_b64 exec, s[82:83]
    s_cbranch_execz L_h2_s3
    buffer_load_dwordx4 v[36:39], v187, s[16:19], s67 offen offset:3072 sc1
L_h2_s3:
    s_mov_b64 exec, s[84:85]
    s_cbranch_execz L_h2_s4
    buffer_load_dwordx4 v[40:43], v187, s[16:19], s68 offen offset:0 sc1
L_h2_s4:
    s_mov_b64 exec, s[86:87]
    s_cbranch_execz L_h2_s5
    buffer_load_dwordx4 v[44:47], v187, s[16:19], s68 offen offset:1024 sc1
L_h2_s5:
    s_mov_b64 exec, s[88:89]
    s_cbranch_execz L_h2_s6
    buffer_load_dwordx4 v[48:51], v187, s[16:19], s68 offen offset:2048 sc1
L_h2_s6:
    s_mov_b64 exec, s[90:91]
    s_cbranch_execz L_h2_s7
    buffer_load_dwordx4 v[52:55], v187, s[16:19], s68 offen offset:3072 sc1
L_h2_s7:
    s_sub_u32 s41, s41, 1
    s_waitcnt vmcnt(0)
    s_mov_b64 s[44:45], 0
    s_mov_b64 exec, s[76:77]
    s_cbranch_execz L_h2_c0
    v_cmp_ne_u32 s[76:77], v195, v25
    v_cmp_ne_u32 vcc, v195, v27
    s_or_b64 s[76:77], s[76:77], vcc
    s_or_b64 s[44:45], s[44:45], s[76:77]
L_h2_c0:
    s_mov_b64 exec, s[78:79]
    s_cbranch_execz L_h2_c1
    v_cmp_ne_u32 s[78:79], v195, v29
    v_cmp_ne_u32 vcc, v195, v31
    s_or_b64 s[78:79], s[78:79], vcc
    s_or_b64 s[44:45], s[44:45], s[78:79]
L_h2_c1:
    s_mov_b64 exec, s[80:81]
    s_cbranch_execz L_h2_c2
    v_cmp_ne_u32 s[80:81], v195, v33
    v_cmp_ne_u32 vcc, v195, v35
    s_or_b64 s[80:81], s[80:81], vcc
    s_or_b64 s[44:45], s[44:45], s[80:81]
L_h2_c2:
    s_mov_b64 exec, s[82:83]
    s_cbranch_execz L_h2_c3
    v_cmp_ne_u32 s[82:83], v195, v37
    v_cmp_ne_u32 vcc, v195, v39
    s_or_b64 s[82:83], s[82:83], vcc
    s_or_b64 s[44:45], s[44:45], s[82:83]
L_h2_c3:
    s_mov_b64 exec, s[84:85]
    s_cbranch_execz L_h2_c4
    v_cmp_ne_u32 s[84:85], v195, v41
    v_cmp_ne_u32 vcc, v195, v43
    s_or_b64 s[84:85], s[84:85], vcc
    s_or_b64 s[44:45], s[44:45], s[84:85]
L_h2_c4:
    s_mov_b64 exec, s[86:87]
    s_cbranch_execz L_h2_c5
    v_cmp_ne_u32 s[86:87], v195, v45
    v_cmp_ne_u32 vcc, v195, v47
    s_or_b64 s[86:87], s[86:87], vcc
    s_or_b64 s[44:45], s[44:45], s[86:87]
L_h2_c5:
    s_mov_b64 exec, s[88:89]
    s_cbranch_execz L_h2_c6
    v_cmp_ne_u32 s[88:89], v195, v49
    v_cmp_ne_u32 vcc, v195, v51
    s_or_b64 s[88:89], s[88:89], vcc
    s_or_b64 s[44:45], s[44:45], s[88:89]
L_h2_c6:
    s_mov_b64 exec, s[90:91]
    s_cbranch_execz L_h2_c7
    v_cmp_ne_u32 s[90:91], v195, v53
    v_cmp_ne_u32 vcc, v195, v55
    s_or_b64 s[90:91], s[90:91], vcc
    s_or_b64 s[44:45], s[44:45], s[90:91]
L_h2_c7:
    s_cmp_lg_u64 s[44:45], 0
    s_cbranch_scc0 L_h2_ok
    s_cmp_lg_u32 s41, 0
    s_cbranch_scc1 L_h2_loop
L_h2_ok:
    s_mov_b64 exec, -1
    v_add_f32 v12, v24, v28
    v_add_f32 v13, v26, v30
    v_add_f32 v14, v32, v36
    v_add_f32 v15, v34, v38
    v_add_f32 v12, v12, v40
    v_add_f32 v13, v13, v42
    v_add_f32 v14, v14, v44
    v_add_f32 v15, v15, v46
    v_add_f32 v12, v12, v48
    v_add_f32 v13, v13, v50
    v_add_f32 v14, v14, v52
    v_add_f32 v15, v15, v54
    v_add_f32 v12, v12, v14
    v_add_f32 v13, v13, v15
    s_nop 1
    v_add_f32_dpp v12, v12, v12 row_ror:8 row_mask:0xf bank_mask:0xf
    v_add_f32_dpp v13, v13, v13 row_ror:8 row_mask:0xf bank_mask:0xf
    v_mov_b32 v20, v12
    v_mov_b32 v21, v13
    s_nop 1
    v_permlane16_swap_b32 v12, v20
    v_permlane16_swap_b32 v13, v21
    v_add_f32 v12, v12, v20
    v_add_f32 v13, v13, v21
    v_mov_b32 v20, v12
    v_mov_b32 v21, v13
    s_nop 1
    v_permlane32_swap_b32 v12, v20
    v_permlane32_swap_b32 v13, v21
    v_add_f32 v12, v12, v20
    v_add_f32 v13, v13, v21
    s_mov_b64 exec, 0xff
    ds_write_b64 v191, v[12:13] offset:5632
    s_mov_b64 exec, -1
    s_waitcnt lgkmcnt(0)
    s_barrier
    s_cmp_lg_u32 s3, 0
    s_cbranch_scc1 L_end
    ds_read_b32 v8, v192 offset:5632
    ds_read_b32 v9, v192 offset:5696
    ds_read_b32 v10, v192 offset:5760
    ds_read_b32 v11, v192 offset:5824
    ds_read_b32 v6, v192 offset:5568
    ds_read_b32 v12, v192 offset:5504
    s_mov_b64 exec, 0xffff
    s_waitcnt lgkmcnt(0)
    v_add_f32 v8, v8, v9
    v_add_f32 v10, v10, v11
    v_add_f32 v8, v8, v10
    v_cvt_pk_bf16_f32 v8, v8, v8
    v_and_b32 v8, 0xffff0000, v8
    v_add_f32 v8, v6, v8
    v_cvt_pk_bf16_f32 v8, v8, v8
    v_and_b32 v8, 0xffff0000, v8
    v_add_f32 v8, v8, v12
    v_cvt_pk_bf16_f32 v8, v8, v8
    buffer_store_short v8, v193, s[20:23], s69 offen
    s_cmp_lg_u32 s4, 0
    s_cbranch_scc1 L_fin
    s_mov_b64 exec, 1
    buffer_store_dword v195, v194, s[16:19], 0 offen sc1
L_fin:
    s_endpgm
L_notw0:
    s_cmp_eq_u32 s3, 1
    s_cbranch_scc1 L_bsum
    s_cmp_lg_u32 s3, 2
    s_cbranch_scc1 L_h1wait
    s_waitcnt vmcnt(0)
    s_mov_b64 s[76:77], -1
    s_mov_b32 s41, 400000
    buffer_load_dwordx4 v[216:219], v188, s[16:19], s65 offen sc1
L_h1_loop:
    s_waitcnt vmcnt(0)
    v_cmp_eq_u32 vcc, v195, v219
    s_andn2_b64 s[76:77], s[76:77], vcc
    s_mov_b64 exec, vcc
    v_mov_b32 v8, v216
    v_mov_b32 v9, v217
    v_mov_b32 v10, v218
    s_mov_b64 exec, s[76:77]
    s_cbranch_execz L_h1_ok
    buffer_load_dwordx4 v[216:219], v188, s[16:19], s65 offen sc1
    s_sub_u32 s41, s41, 1
    s_cmp_lg_u32 s41, 0
    s_cbranch_scc1 L_h1_loop
L_h1_ok:
    s_mov_b64 exec, -1
    v_mov_b32 v20, v10
    s_nop 1
    v_max_f32_dpp v20, v20, v20 row_ror:8 row_mask:0xf bank_mask:0xf
    v_mov_b32 v21, v20
    s_nop 1
    v_permlane16_swap_b32 v20, v21
    v_max_f32 v20, v20, v21
    v_mov_b32 v21, v20
    s_nop 1
    v_permlane32_swap_b32 v20, v21
    v_max_f32 v20, v20, v21
    v_sub_f32 v10, v10, v20
    v_exp_f32 v10, v10
    s_nop 0
    v_mul_f32 v8, v8, v10
    v_mul_f32 v9, v9, v10
    s_nop 1
    v_add_f32_dpp v10, v10, v10 row_ror:8 row_mask:0xf bank_mask:0xf
    v_add_f32_dpp v8, v8, v8 row_ror:8 row_mask:0xf bank_mask:0xf
    v_add_f32_dpp v9, v9, v9 row_ror:8 row_mask:0xf bank_mask:0xf
    v_mov_b32 v20, v10
    v_mov_b32 v21, v8
    v_mov_b32 v22, v9
    s_nop 1
    v_permlane16_swap_b32 v10, v20
    v_permlane16_swap_b32 v8, v21
    v_permlane16_swap_b32 v9, v22
    v_add_f32 v10, v10, v20
    v_add_f32 v8, v8, v21
    v_add_f32 v9, v9, v22
    v_mov_b32 v20, v10
    v_mov_b32 v21, v8
    v_mov_b32 v22, v9
    s_nop 1
    v_permlane32_swap_b32 v10, v20
    v_permlane32_swap_b32 v8, v21
    v_permlane32_swap_b32 v9, v22
    v_add_f32 v10, v10, v20
    v_add_f32 v8, v8, v21
    v_add_f32 v9, v9, v22
    v_rcp_f32 v10, v10
    s_nop 0
    v_mul_f32 v8, v8, v10
    v_mul_f32 v9, v9, v10
    v_cvt_pk_bf16_f32 v9, v8, v9
    v_lshlrev_b32 v8, 16, v9
    v_and_b32 v9, 0xffff0000, v9
    s_mov_b64 exec, 0xff
    ds_write_b64 v186, v[8:9] offset:5888
    s_mov_b64 exec, -1
    s_waitcnt lgkmcnt(0)
    s_branch L_h1wait
L_bsum:
    s_cmp_eq_u32 s58, 0
    s_cbranch_scc1 L_h1wait
    s_mov_b64 s[76:77], -1
    s_mov_b64 s[78:79], -1
    s_mov_b64 s[80:81], -1
    s_mov_b32 s82, -1
    s_mov_b32 s83, 0
    s_mov_b32 s41, 400000
    s_branch L_b_chk
L_b_loop:
    s_mov_b64 exec, s[76:77]
    s_cbranch_execz L_b_s0
    buffer_load_dwordx4 v[196:199], v187, s[16:19], s60 offen offset:0 sc1
L_b_s0:
    s_mov_b64 exec, s[78:79]
    s_cbranch_execz L_b_s1
    buffer_load_dwordx4 v[200:203], v187, s[16:19], s60 offen offset:1024 sc1
L_b_s1:
    s_mov_b64 exec, s[80:81]
    s_cbranch_execz L_b_s2
    buffer_load_dwordx4 v[204:207], v187, s[16:19], s60 offen offset:2048 sc1
L_b_s2:
    s_mov_b64 exec, s[82:83]
    s_cbranch_execz L_b_s3
    buffer_load_dwordx4 v[208:211], v187, s[16:19], s60 offen offset:3072 sc1
L_b_s3:
L_b_chk:
    s_sub_u32 s41, s41, 1
    s_waitcnt vmcnt(0)
    s_mov_b64 s[44:45], 0
    s_mov_b64 exec, s[76:77]
    s_cbranch_execz L_b_c0
    v_cmp_ne_u32 s[76:77], v195, v197
    v_cmp_ne_u32 vcc, v195, v199
    s_or_b64 s[76:77], s[76:77], vcc
    s_or_b64 s[44:45], s[44:45], s[76:77]
L_b_c0:
    s_mov_b64 exec, s[78:79]
    s_cbranch_execz L_b_c1
    v_cmp_ne_u32 s[78:79], v195, v201
    v_cmp_ne_u32 vcc, v195, v203
    s_or_b64 s[78:79], s[78:79], vcc
    s_or_b64 s[44:45], s[44:45], s[78:79]
L_b_c1:
    s_mov_b64 exec, s[80:81]
    s_cbranch_execz L_b_c2
    v_cmp_ne_u32 s[80:81], v195, v205
    v_cmp_ne_u32 vcc, v195, v207
    s_or_b64 s[80:81], s[80:81], vcc
    s_or_b64 s[44:45], s[44:45], s[80:81]
L_b_c2:
    s_mov_b64 exec, s[82:83]
    s_cbranch_execz L_b_c3
    v_cmp_ne_u32 s[82:83], v195, v209
    v_cmp_ne_u32 vcc, v195, v211
    s_or_b64 s[82:83], s[82:83], vcc
    s_or_b64 s[44:45], s[44:45], s[82:83]
L_b_c3:
    s_cmp_lg_u64 s[44:45], 0
    s_cbranch_scc0 L_b_ok
    s_cmp_lg_u32 s41, 0
    s_cbranch_scc1 L_b_loop
L_b_ok:
    s_mov_b64 exec, -1
    s_waitcnt vmcnt(0)
    v_add_f32 v8, v196, v200
    v_add_f32 v9, v198, v202
    v_add_f32 v8, v8, v204
    v_add_f32 v9, v9, v206
    v_add_f32 v8, v8, v208
    v_add_f32 v9, v9, v210
    v_mov_b32 v6, v212
    s_nop 1
    v_add_f32_dpp v8, v8, v8 row_ror:8 row_mask:0xf bank_mask:0xf
    v_add_f32_dpp v9, v9, v9 row_ror:8 row_mask:0xf bank_mask:0xf
    v_mov_b32 v20, v8
    v_mov_b32 v21, v9
    s_nop 1
    v_permlane16_swap_b32 v8, v20
    v_permlane16_swap_b32 v9, v21
    v_add_f32 v8, v8, v20
    v_add_f32 v9, v9, v21
    v_mov_b32 v20, v8
    v_mov_b32 v21, v9
    s_nop 1
    v_permlane32_swap_b32 v8, v20
    v_permlane32_swap_b32 v9, v21
    v_add_f32 v8, v8, v20
    v_add_f32 v9, v9, v21
    v_cvt_pk_bf16_f32 v8, v8, v8
    v_and_b32 v8, 0xffff0000, v8
    v_cvt_pk_bf16_f32 v9, v9, v9
    v_and_b32 v9, 0xffff0000, v9
    v_lshlrev_b32 v6, 16, v6
    s_mov_b64 exec, 0xffff
    ds_write_b32 v192, v6 offset:5568
    s_mov_b64 exec, 0xff
    ds_write_b64 v186, v[8:9] offset:5504
    s_mov_b64 exec, -1
    s_waitcnt lgkmcnt(0)
    s_branch L_h1wait
L_helper:
    v_mov_b32 v12, 0
    v_mov_b32 v13, 0
    v_mov_b32 v14, 0
    v_mov_b32 v15, 0
    ds_write_b128 v2, v[12:15] offset:6144
    ds_write_b128 v2, v[12:15] offset:7168
    v_mov_b32 v13, 4
    ds_write_b32 v12, v13 offset:6144
    s_mov_b32 s42, 0x01000100
    s_mov_b32 s43, 0x03020302
    s_waitcnt vmcnt(16)
    v_lshlrev_b32 v48, 16, v8
    v_and_b32 v49, 0xffff0000, v8
    v_lshlrev_b32 v50, 16, v9
    v_and_b32 v51, 0xffff0000, v9
    v_lshlrev_b32 v52, 16, v10
    v_and_b32 v53, 0xffff0000, v10
    v_lshlrev_b32 v54, 16, v11
    v_and_b32 v55, 0xffff0000, v11
    v_add_f32 v4, v48, v49
    v_add_f32 v4, v4, v50
    v_add_f32 v4, v4, v51
    v_add_f32 v4, v4, v52
    v_add_f32 v4, v4, v53
    v_add_f32 v4, v4, v54
    v_add_f32 v4, v4, v55
    s_nop 1
    v_add_f32_dpp v4, v4, v4 row_ror:8 row_mask:0xf bank_mask:0xf
    s_nop 1
    v_add_f32_dpp v4, v4, v4 row_ror:4 row_mask:0xf bank_mask:0xf
    s_nop 1
    v_add_f32_dpp v4, v4, v4 row_ror:2 row_mask:0xf bank_mask:0xf
    s_nop 1
    v_add_f32_dpp v4, v4, v4 row_ror:1 row_mask:0xf bank_mask:0xf
    v_mov_b32 v5, v4
    s_nop 1
    v_permlane16_swap_b32 v4, v5
    s_nop 1
    v_add_f32 v4, v4, v5
    v_mov_b32 v5, v4
    s_nop 1
    v_permlane32_swap_b32 v4, v5
    s_nop 1
    v_add_f32 v4, v4, v5
    v_mul_f32 v4, 0x3b000000, v4
    v_sub_f32 v6, v48, v4
    v_mul_f32 v5, v6, v6
    v_sub_f32 v6, v49, v4
    v_fmac_f32 v5, v6, v6
    v_sub_f32 v6, v50, v4
    v_fmac_f32 v5, v6, v6
    v_sub_f32 v6, v51, v4
    v_fmac_f32 v5, v6, v6
    v_sub_f32 v6, v52, v4
    v_fmac_f32 v5, v6, v6
    v_sub_f32 v6, v53, v4
    v_fmac_f32 v5, v6, v6
    v_sub_f32 v6, v54, v4
    v_fmac_f32 v5, v6, v6
    v_sub_f32 v6, v55, v4
    v_fmac_f32 v5, v6, v6
    s_nop 1
    v_add_f32_dpp v5, v5, v5 row_ror:8 row_mask:0xf bank_mask:0xf
    s_nop 1
    v_add_f32_dpp v5, v5, v5 row_ror:4 row_mask:0xf bank_mask:0xf
    s_nop 1
    v_add_f32_dpp v5, v5, v5 row_ror:2 row_mask:0xf bank_mask:0xf
    s_nop 1
    v_add_f32_dpp v5, v5, v5 row_ror:1 row_mask:0xf bank_mask:0xf
    v_mov_b32 v6, v5
    s_nop 1
    v_permlane16_swap_b32 v5, v6
    s_nop 1
    v_add_f32 v5, v5, v6
    v_mov_b32 v6, v5
    s_nop 1
    v_permlane32_swap_b32 v5, v6
    s_nop 1
    v_add_f32 v5, v5, v6
    v_mul_f32 v5, 0x3b000000, v5
    v_cvt_pk_bf16_f32 v4, v4, v4
    v_and_b32 v4, 0xffff0000, v4
    v_cvt_pk_bf16_f32 v5, v5, v5
    v_and_b32 v5, 0xffff0000, v5
    v_add_f32 v5, 0x37280000, v5
    v_cvt_pk_bf16_f32 v5, v5, v5
    v_and_b32 v5, 0xffff0000, v5
    v_sqrt_f32 v5, v5
    s_nop 0
    v_cvt_pk_bf16_f32 v5, v5, v5
    v_and_b32 v5, 0xffff0000, v5
    v_rcp_f32 v5, v5
    v_sub_f32 v48, v48, v4
    v_cvt_pk_bf16_f32 v48, v48, v48
    v_and_b32 v48, 0xffff0000, v48
    v_mul_f32 v48, v48, v5
    v_sub_f32 v49, v49, v4
    v_cvt_pk_bf16_f32 v49, v49, v49
    v_and_b32 v49, 0xffff0000, v49
    v_mul_f32 v49, v49, v5
    v_sub_f32 v50, v50, v4
    v_cvt_pk_bf16_f32 v50, v50, v50
    v_and_b32 v50, 0xffff0000, v50
    v_mul_f32 v50, v50, v5
    v_sub_f32 v51, v51, v4
    v_cvt_pk_bf16_f32 v51, v51, v51
    v_and_b32 v51, 0xffff0000, v51
    v_mul_f32 v51, v51, v5
    v_sub_f32 v52, v52, v4
    v_cvt_pk_bf16_f32 v52, v52, v52
    v_and_b32 v52, 0xffff0000, v52
    v_mul_f32 v52, v52, v5
    v_sub_f32 v53, v53, v4
    v_cvt_pk_bf16_f32 v53, v53, v53
    v_and_b32 v53, 0xffff0000, v53
    v_mul_f32 v53, v53, v5
    v_sub_f32 v54, v54, v4
    v_cvt_pk_bf16_f32 v54, v54, v54
    v_and_b32 v54, 0xffff0000, v54
    v_mul_f32 v54, v54, v5
    v_sub_f32 v55, v55, v4
    v_cvt_pk_bf16_f32 v55, v55, v55
    v_and_b32 v55, 0xffff0000, v55
    v_mul_f32 v55, v55, v5
    v_cvt_pk_bf16_f32 v8, v48, v49
    v_cvt_pk_bf16_f32 v9, v50, v51
    v_cvt_pk_bf16_f32 v10, v52, v53
    v_cvt_pk_bf16_f32 v11, v54, v55
    ds_write_b128 v2, v[8:11] offset:0
    s_lshl_b32 s38, s5, 7
    v_lshl_add_u32 v4, v21, 5, s38
    s_waitcnt lgkmcnt(0)
    s_add_u32 s40, s40, 0x9e3779b9
    ds_read_b128 v[24:27], v4 offset:0
    ds_read_b128 v[28:31], v4 offset:16
    v_mov_b32 v1, s40
    s_waitcnt lgkmcnt(0)
    v_perm_b32 v7, v24, v24, s42
    v_and_b32 v32, v7, v16
    v_and_b32 v33, v7, v17
    v_and_b32 v34, v7, v18
    v_and_b32 v35, v7, v19
    v_perm_b32 v7, v24, v24, s43
    v_and_b32 v36, v7, v16
    v_and_b32 v37, v7, v17
    v_and_b32 v38, v7, v18
    v_and_b32 v39, v7, v19
    s_waitcnt vmcnt(15)
    v_mfma_f32_16x16x32_bf16 v[40:43], v[32:35], v[64:67], 0
    v_perm_b32 v7, v25, v25, s42
    v_and_b32 v32, v7, v16
    v_and_b32 v33, v7, v17
    v_and_b32 v34, v7, v18
    v_and_b32 v35, v7, v19
    s_waitcnt vmcnt(14)
    v_mfma_f32_16x16x32_bf16 v[40:43], v[36:39], v[68:71], v[40:43]
    v_perm_b32 v7, v25, v25, s43
    v_and_b32 v36, v7, v16
    v_and_b32 v37, v7, v17
    v_and_b32 v38, v7, v18
    v_and_b32 v39, v7, v19
    s_waitcnt vmcnt(13)
    v_mfma_f32_16x16x32_bf16 v[40:43], v[32:35], v[72:75], v[40:43]
    v_perm_b32 v7, v26, v26, s42
    v_and_b32 v32, v7, v16
    v_and_b32 v33, v7, v17
    v_and_b32 v34, v7, v18
    v_and_b32 v35, v7, v19
    s_waitcnt vmcnt(12)
    v_mfma_f32_16x16x32_bf16 v[40:43], v[36:39], v[76:79], v[40:43]
    v_perm_b32 v7, v26, v26, s43
    v_and_b32 v36, v7, v16
    v_and_b32 v37, v7, v17
    v_and_b32 v38, v7, v18
    v_and_b32 v39, v7, v19
    s_waitcnt vmcnt(11)
    v_mfma_f32_16x16x32_bf16 v[40:43], v[32:35], v[80:83], v[40:43]
    v_perm_b32 v7, v27, v27, s42
    v_and_b32 v32, v7, v16
    v_and_b32 v33, v7, v17
    v_and_b32 v34, v7, v18
    v_and_b32 v35, v7, v19
    s_waitcnt vmcnt(10)
    v_mfma_f32_16x16x32_bf16 v[40:43], v[36:39], v[84:87], v[40:43]
    v_perm_b32 v7, v27, v27, s43
    v_and_b32 v36, v7, v16
    v_and_b32 v37, v7, v17
    v_and_b32 v38, v7, v18
    v_and_b32 v39, v7, v19
    s_waitcnt vmcnt(9)
    v_mfma_f32_16x16x32_bf16 v[40:43], v[32:35], v[88:91], v[40:43]
    v_perm_b32 v7, v28, v28, s42
    v_and_b32 v32, v7, v16
    v_and_b32 v33, v7, v17
    v_and_b32 v34, v7, v18
    v_and_b32 v35, v7, v19
    s_waitcnt vmcnt(8)
    v_mfma_f32_16x16x32_bf16 v[40:43], v[36:39], v[92:95], v[40:43]
    v_perm_b32 v7, v28, v28, s43
    v_and_b32 v36, v7, v16
    v_and_b32 v37, v7, v17
    v_and_b32 v38, v7, v18
    v_and_b32 v39, v7, v19
    s_waitcnt vmcnt(7)
    v_mfma_f32_16x16x32_bf16 v[40:43], v[32:35], v[96:99], v[40:43]
    v_perm_b32 v7, v29, v29, s42
    v_and_b32 v32, v7, v16
    v_and_b32 v33, v7, v17
    v_and_b32 v34, v7, v18
    v_and_b32 v35, v7, v19
    s_waitcnt vmcnt(6)
    v_mfma_f32_16x16x32_bf16 v[40:43], v[36:39], v[100:103], v[40:43]
    v_perm_b32 v7, v29, v29, s43
    v_and_b32 v36, v7, v16
    v_and_b32 v37, v7, v17
    v_and_b32 v38, v7, v18
    v_and_b32 v39, v7, v19
    s_waitcnt vmcnt(5)
    v_mfma_f32_16x16x32_bf16 v[40:43], v[32:35], v[104:107], v[40:43]
    v_perm_b32 v7, v30, v30, s42
    v_and_b32 v32, v7, v16
    v_and_b32 v33, v7, v17
    v_and_b32 v34, v7, v18
    v_and_b32 v35, v7, v19
    s_waitcnt vmcnt(4)
    v_mfma_f32_16x16x32_bf16 v[40:43], v[36:39], v[108:111], v[40:43]
    v_perm_b32 v7, v30, v30, s43
    v_and_b32 v36, v7, v16
    v_and_b32 v37, v7, v17
    v_and_b32 v38, v7, v18
    v_and_b32 v39, v7, v19
    s_waitcnt vmcnt(3)
    v_mfma_f32_16x16x32_bf16 v[40:43], v[32:35], v[112:115], v[40:43]
    v_perm_b32 v7, v31, v31, s42
    v_and_b32 v32, v7, v16
    v_and_b32 v33, v7, v17
    v_and_b32 v34, v7, v18
    v_and_b32 v35, v7, v19
    s_waitcnt vmcnt(2)
    v_mfma_f32_16x16x32_bf16 v[40:43], v[36:39], v[116:119], v[40:43]
    v_perm_b32 v7, v31, v31, s43
    v_and_b32 v36, v7, v16
    v_and_b32 v37, v7, v17
    v_and_b32 v38, v7, v18
    v_and_b32 v39, v7, v19
    s_waitcnt vmcnt(1)
    v_mfma_f32_16x16x32_bf16 v[40:43], v[32:35], v[120:123], v[40:43]
    s_nop 1
    s_waitcnt vmcnt(0)
    v_mfma_f32_16x16x32_bf16 v[40:43], v[36:39], v[124:127], v[40:43]
    v_lshlrev_b32 v4, 6, v20
    v_lshl_add_u32 v4, v21, 5, v4
    v_mov_b32 v9, v1
    v_mov_b32 v11, v1
    v_mov_b32 v13, v1
    v_mov_b32 v15, v1
    s_lshl_b32 s38, s2, 10
    s_add_u32 s38, s38, 65536
    s_nop 1
    v_mov_b32 v5, 0
    s_mov_b32 s41, 6400000
L_vw:
    ds_read_b32 v50, v5 offset:1280
    s_sub_u32 s41, s41, 1
    s_waitcnt lgkmcnt(0)
    v_readfirstlane_b32 s39, v50
    s_cmp_eq_u32 s41, 0
    s_cbranch_scc1 L_vwx
    s_cmp_lt_u32 s39, 0x40000000
    s_cbranch_scc1 L_vw
L_vwx:
    v_and_b32 v50, 0xfffffff, v50
    v_mov_b32 v48, v40
    v_mov_b32 v49, v41
    v_mov_b32 v51, v1
    v_mov_b32 v52, v42
    v_mov_b32 v53, v43
    v_mov_b32 v54, v50
    v_mov_b32 v55, v1
    s_mov_b32 exec_hi, 0
    buffer_store_dwordx4 v[48:51], v4, s[16:19], s38 offen sc1
    buffer_store_dwordx4 v[52:55], v4, s[16:19], s38 offen offset:16 sc1
    s_mov_b64 exec, -1
    s_lshl_b32 s38, s4, 13
    s_add_u32 s38, s38, 65536
    s_add_u32 s39, s38, 4096
    s_mov_b64 s[76:77], -1
    s_mov_b64 s[78:79], -1
    s_mov_b64 s[80:81], -1
    s_mov_b64 s[82:83], -1
    s_mov_b64 s[84:85], -1
    s_mov_b64 s[86:87], -1
    s_mov_b64 s[88:89], -1
    s_mov_b64 s[90:91], -1
    s_mov_b32 s41, 400000
L_q_loop:
    s_mov_b64 exec, s[76:77]
    s_cbranch_execz L_q_s0
    buffer_load_dwordx4 v[64:67], v2, s[16:19], s38 offen offset:0 sc1
L_q_s0:
    s_mov_b64 exec, s[78:79]
    s_cbranch_execz L_q_s1
    buffer_load_dwordx4 v[68:71], v2, s[16:19], s38 offen offset:1024 sc1
L_q_s1:
    s_mov_b64 exec, s[80:81]
    s_cbranch_execz L_q_s2
    buffer_load_dwordx4 v[72:75], v2, s[16:19], s38 offen offset:2048 sc1
L_q_s2:
    s_mov_b64 exec, s[82:83]
    s_cbranch_execz L_q_s3
    buffer_load_dwordx4 v[76:79], v2, s[16:19], s38 offen offset:3072 sc1
L_q_s3:
    s_mov_b64 exec, s[84:85]
    s_cbranch_execz L_q_s4
    buffer_load_dwordx4 v[80:83], v2, s[16:19], s39 offen offset:0 sc1
L_q_s4:
    s_mov_b64 exec, s[86:87]
    s_cbranch_execz L_q_s5
    buffer_load_dwordx4 v[84:87], v2, s[16:19], s39 offen offset:1024 sc1
L_q_s5:
    s_mov_b64 exec, s[88:89]
    s_cbranch_execz L_q_s6
    buffer_load_dwordx4 v[88:91], v2, s[16:19], s39 offen offset:2048 sc1
L_q_s6:
    s_mov_b64 exec, s[90:91]
    s_cbranch_execz L_q_s7
    buffer_load_dwordx4 v[92:95], v2, s[16:19], s39 offen offset:3072 sc1
L_q_s7:
    s_sub_u32 s41, s41, 1
    s_waitcnt vmcnt(0)
    s_mov_b64 s[44:45], 0
    s_mov_b64 exec, s[76:77]
    s_cbranch_execz L_q_c0
    v_cmp_ne_u32 s[76:77], v1, v67
    s_or_b64 s[44:45], s[44:45], s[76:77]
L_q_c0:
    s_mov_b64 exec, s[78:79]
    s_cbranch_execz L_q_c1
    v_cmp_ne_u32 s[78:79], v1, v71
    s_or_b64 s[44:45], s[44:45], s[78:79]
L_q_c1:
    s_mov_b64 exec, s[80:81]
    s_cbranch_execz L_q_c2
    v_cmp_ne_u32 s[80:81], v1, v75
    s_or_b64 s[44:45], s[44:45], s[80:81]
L_q_c2:
    s_mov_b64 exec, s[82:83]
    s_cbranch_execz L_q_c3
    v_cmp_ne_u32 s[82:83], v1, v79
    s_or_b64 s[44:45], s[44:45], s[82:83]
L_q_c3:
    s_mov_b64 exec, s[84:85]
    s_cbranch_execz L_q_c4
    v_cmp_ne_u32 s[84:85], v1, v83
    s_or_b64 s[44:45], s[44:45], s[84:85]
L_q_c4:
    s_mov_b64 exec, s[86:87]
    s_cbranch_execz L_q_c5
    v_cmp_ne_u32 s[86:87], v1, v87
    s_or_b64 s[44:45], s[44:45], s[86:87]
L_q_c5:
    s_mov_b64 exec, s[88:89]
    s_cbranch_execz L_q_c6
    v_cmp_ne_u32 s[88:89], v1, v91
    s_or_b64 s[44:45], s[44:45], s[88:89]
L_q_c6:
    s_mov_b64 exec, s[90:91]
    s_cbranch_execz L_q_c7
    v_cmp_ne_u32 s[90:91], v1, v95
    s_or_b64 s[44:45], s[44:45], s[90:91]
L_q_c7:
    s_cmp_lg_u64 s[44:45], 0
    s_cbranch_scc0 L_q_ok
    s_cmp_lg_u32 s41, 0
    s_cbranch_scc1 L_q_loop
L_q_ok:
    s_mov_b64 exec, -1
    v_add_f32 v4, v64, v68
    v_add_f32 v5, v65, v69
    v_add_f32 v4, v4, v72
    v_add_f32 v5, v5, v73
    v_add_f32 v4, v4, v76
    v_add_f32 v5, v5, v77
    v_add_f32 v4, v4, v80
    v_add_f32 v5, v5, v81
    v_add_f32 v4, v4, v84
    v_add_f32 v5, v5, v85
    v_add_f32 v4, v4, v88
    v_add_f32 v5, v5, v89
    v_add_f32 v4, v4, v92
    v_add_f32 v5, v5, v93
    v_cvt_pk_bf16_f32 v4, v4, v5
    v_lshlrev_b32 v5, 2, v0
    ds_write_b32 v5, v4 offset:1024
    s_waitcnt lgkmcnt(0)
    s_barrier
    s_andn2_b32 s38, s2, 31
    s_lshl_b32 s38, s38, 10
    s_add_u32 s38, s38, 65536
    v_and_b32 v4, 31, v0
    v_lshlrev_b32 v4, 10, v4
    s_mov_b64 s[76:77], -1
    s_mov_b32 s41, 400000
L_vt_loop:
    s_mov_b64 exec, s[76:77]
    buffer_load_dwordx4 v[64:67], v4, s[16:19], s38 offen sc1
    s_sub_u32 s41, s41, 1
    s_waitcnt vmcnt(0)
    v_cmp_ne_u32 s[76:77], v1, v67
    s_cmp_lg_u64 s[76:77], 0
    s_cbranch_scc0 L_vt_ok
    s_cmp_lg_u32 s41, 0
    s_cbranch_scc1 L_vt_loop
L_vt_ok:
    s_mov_b64 exec, -1
    v_mov_b32 v6, v66
    s_nop 1
    v_add_u32_dpp v6, v6, v6 row_ror:8 row_mask:0xf bank_mask:0xf
    s_nop 1
    v_add_u32_dpp v6, v6, v6 row_ror:4 row_mask:0xf bank_mask:0xf
    s_nop 1
    v_add_u32_dpp v6, v6, v6 row_ror:2 row_mask:0xf bank_mask:0xf
    s_nop 1
    v_add_u32_dpp v6, v6, v6 row_ror:1 row_mask:0xf bank_mask:0xf
    v_mov_b32 v7, v6
    s_nop 1
    v_permlane16_swap_b32 v6, v7
    v_add_u32 v6, v6, v7
    s_nop 0
    v_readfirstlane_b32 s38, v6
    s_nop 0
    s_bfe_u32 s44, s38, 0x70000
    s_bfe_u32 s45, s38, 0x70007
    s_sub_i32 s44, s45, s44
    s_bfe_u32 s45, s38, 0x7000e
    s_bfe_u32 s46, s38, 0x70015
    s_sub_i32 s45, s46, s45
    s_min_i32 s46, s44, s45
    s_max_i32 s47, s44, s45
    s_mov_b32 s39, 0
    s_cmp_ge_i32 s46, 16
    s_cselect_b32 s39, 0xff55, s39
    s_cmp_le_i32 s47, -16
    s_cselect_b32 s39, 0xffaa, s39
    s_or_b32 s39, s39, 0x10000
    v_mov_b32 v6, s39
    v_mov_b32 v7, 0
    ds_write_b32 v7, v6 offset:1284
    s_waitcnt lgkmcnt(0)
    s_lshl_b32 s38, s4, 1
    s_or_b32 s38, s38, 1
    s_and_b32 s38, s38, 7
    s_cmp_lg_u32 s38, s5
    s_cbranch_scc1 L_noffn
    s_cmp_ge_u32 s4, 28
    s_cbranch_scc1 L_noffn
    s_mov_b32 s20, s64
    s_mov_b32 s21, s65
    s_mov_b32 s22, 1835008
    s_mov_b32 s23, 0x20000
    s_mov_b32 s24, s66
    s_mov_b32 s25, s67
    s_mov_b32 s26, 1835008
    s_mov_b32 s27, 0x20000
    v_bfe_u32 v22, v0, 1, 2
    v_cmp_eq_u32 vcc, 0, v22
    s_nop 1
    v_cndmask_b32 v48, 0, v23, vcc
    v_cmp_eq_u32 vcc, 1, v22
    s_nop 1
    v_cndmask_b32 v49, 0, v23, vcc
    v_cmp_eq_u32 vcc, 2, v22
    s_nop 1
    v_cndmask_b32 v50, 0, v23, vcc
    v_cmp_eq_u32 vcc, 3, v22
    s_nop 1
    v_cndmask_b32 v51, 0, v23, vcc
    v_lshrrev_b32 v3, 3, v0
    s_mov_b32 s38, 229376
    v_mul_lo_u32 v4, v3, s38
    v_and_b32 v5, 7, v0
    v_lshl_add_u32 v4, v5, 4, v4
    v_lshlrev_b32 v3, 7, v3
    s_lshl_b32 s38, s4, 7
    s_mov_b32 s39, 8
    v_mov_b32 v40, 0
    v_mov_b32 v41, 0
    v_mov_b32 v42, 0
    v_mov_b32 v43, 0
    v_mov_b32 v44, 0
    v_mov_b32 v45, 0
    v_mov_b32 v46, 0
    v_mov_b32 v47, 0
L_ffn1:
    ds_read_b128 v[24:27], v3 offset:0
    buffer_load_dwordx4 v[64:67], v4, s[20:23], s38 offen nt
    buffer_load_dwordx4 v[68:71], v4, s[24:27], s38 offen nt
    s_add_u32 s38, s38, 3584
    buffer_load_dwordx4 v[72:75], v4, s[20:23], s38 offen nt
    buffer_load_dwordx4 v[76:79], v4, s[24:27], s38 offen nt
    s_add_u32 s38, s38, 3584
    buffer_load_dwordx4 v[80:83], v4, s[20:23], s38 offen nt
    buffer_load_dwordx4 v[84:87], v4, s[24:27], s38 offen nt
    s_add_u32 s38, s38, 3584
    buffer_load_dwordx4 v[88:91], v4, s[20:23], s38 offen nt
    buffer_load_dwordx4 v[92:95], v4, s[24:27], s38 offen nt
    s_add_u32 s38, s38, 3584
    buffer_load_dwordx4 v[96:99], v4, s[20:23], s38 offen nt
    buffer_load_dwordx4 v[100:103], v4, s[24:27], s38 offen nt
    s_add_u32 s38, s38, 3584
    buffer_load_dwordx4 v[104:107], v4, s[20:23], s38 offen nt
    buffer_load_dwordx4 v[108:111], v4, s[24:27], s38 offen nt
    s_add_u32 s38, s38, 3584
    buffer_load_dwordx4 v[112:115], v4, s[20:23], s38 offen nt
    buffer_load_dwordx4 v[116:119], v4, s[24:27], s38 offen nt
    s_add_u32 s38, s38, 3584
    buffer_load_dwordx4 v[120:123], v4, s[20:23], s38 offen nt
    buffer_load_dwordx4 v[124:127], v4, s[24:27], s38 offen nt
    s_add_u32 s38, s38, 3584
    v_add_u32 v3, 16, v3
    s_waitcnt lgkmcnt(0)
    v_perm_b32 v7, v24, v24, s42
    v_and_b32 v32, v7, v48
    v_and_b32 v33, v7, v49
    v_and_b32 v34, v7, v50
    v_and_b32 v35, v7, v51
    v_perm_b32 v7, v24, v24, s43
    v_and_b32 v36, v7, v48
    v_and_b32 v37, v7, v49
    v_and_b32 v38, v7, v50
    v_and_b32 v39, v7, v51
    s_waitcnt vmcnt(14)
    v_mfma_f32_16x16x32_bf16 v[40:43], v[32:35], v[64:67], v[40:43]
    v_mfma_f32_16x16x32_bf16 v[44:47], v[32:35], v[68:71], v[44:47]
    v_perm_b32 v7, v25, v25, s42
    v_and_b32 v32, v7, v48
    v_and_b32 v33, v7, v49
    v_and_b32 v34, v7, v50
    v_and_b32 v35, v7, v51
    s_waitcnt vmcnt(12)
    v_mfma_f32_16x16x32_bf16 v[40:43], v[36:39], v[72:75], v[40:43]
    v_mfma_f32_16x16x32_bf16 v[44:47], v[36:39], v[76:79], v[44:47]
    v_perm_b32 v7, v25, v25, s43
    v_and_b32 v36, v7, v48
    v_and_b32 v37, v7, v49
    v_and_b32 v38, v7, v50
    v_and_b32 v39, v7, v51
    s_waitcnt vmcnt(10)
    v_mfma_f32_16x16x32_bf16 v[40:43], v[32:35], v[80:83], v[40:43]
    v_mfma_f32_16x16x32_bf16 v[44:47], v[32:35], v[84:87], v[44:47]
    v_perm_b32 v7, v26, v26, s42
    v_and_b32 v32, v7, v48
    v_and_b32 v33, v7, v49
    v_and_b32 v34, v7, v50
    v_and_b32 v35, v7, v51
    s_waitcnt vmcnt(8)
    v_mfma_f32_16x16x32_bf16 v[40:43], v[36:39], v[88:91], v[40:43]
    v_mfma_f32_16x16x32_bf16 v[44:47], v[36:39], v[92:95], v[44:47]
    v_perm_b32 v7, v26, v26, s43
    v_and_b32 v36, v7, v48
    v_and_b32 v37, v7, v49
    v_and_b32 v38, v7, v50
    v_and_b32 v39, v7, v51
    s_waitcnt vmcnt(6)
    v_mfma_f32_16x16x32_bf16 v[40:43], v[32:35], v[96:99], v[40:43]
    v_mfma_f32_16x16x32_bf16 v[44:47], v[32:35], v[100:103], v[44:47]
    v_perm_b32 v7, v27, v27, s42
    v_and_b32 v32, v7, v48
    v_and_b32 v33, v7, v49
    v_and_b32 v34, v7, v50
    v_and_b32 v35, v7, v51
    s_waitcnt vmcnt(4)
    v_mfma_f32_16x16x32_bf16 v[40:43], v[36:39], v[104:107], v[40:43]
    v_mfma_f32_16x16x32_bf16 v[44:47], v[36:39], v[108:111], v[44:47]
    v_perm_b32 v7, v27, v27, s43
    v_and_b32 v36, v7, v48
    v_and_b32 v37, v7, v49
    v_and_b32 v38, v7, v50
    v_and_b32 v39, v7, v51
    s_waitcnt vmcnt(2)
    v_mfma_f32_16x16x32_bf16 v[40:43], v[32:35], v[112:115], v[40:43]
    v_mfma_f32_16x16x32_bf16 v[44:47], v[32:35], v[116:119], v[44:47]
    s_nop 1
    s_waitcnt vmcnt(0)
    v_mfma_f32_16x16x32_bf16 v[40:43], v[36:39], v[120:123], v[40:43]
    v_mfma_f32_16x16x32_bf16 v[44:47], v[36:39], v[124:127], v[44:47]
    s_sub_u32 s39, s39, 1
    s_cmp_lg_u32 s39, 0
    s_cbranch_scc1 L_ffn1
    v_lshrrev_b32 v3, 5, v0
    v_bfe_u32 v4, v0, 3, 1
    v_cmp_eq_u32 vcc, v3, v4
    v_lshlrev_b32 v3, 8, v3
    v_lshl_add_u32 v3, v5, 5, v3
    v_bfe_u32 v4, v0, 4, 1
    v_lshl_add_u32 v3, v4, 4, v3
    s_nop 4
    s_mov_b64 exec, vcc
    ds_write_b128 v3, v[40:43] offset:4352
    ds_write_b128 v3, v[44:47] offset:4864
    s_mov_b64 exec, -1
    v_lshlrev_b32 v3, 2, v0
    s_waitcnt lgkmcnt(0)
    ds_read_b32 v4, v3 offset:4352
    ds_read_b32 v5, v3 offset:4608
    ds_read_b32 v6, v3 offset:4864
    ds_read_b32 v7, v3 offset:5120
    s_waitcnt lgkmcnt(0)
    v_add_f32 v4, v4, v5
    v_add_f32 v6, v6, v7
    v_cvt_pk_bf16_f32 v4, v4, v4
    v_and_b32 v4, 0xffff0000, v4
    v_cvt_pk_bf16_f32 v6, v6, v6
    v_and_b32 v6, 0xffff0000, v6
    v_cmp_lt_f32 vcc, 0, v4
    s_nop 1
    v_cndmask_b32 v5, 0, 1.0, vcc
    v_mul_f32 v4, v4, v5
    v_mul_f32 v4, v4, v6
    v_cvt_pk_bf16_f32 v4, v4, v4
    v_lshlrev_b32 v3, 1, v0
    ds_write_b16 v3, v4 offset:5376
    v_lshlrev_b32 v3, 5, v21
    s_waitcnt lgkmcnt(0)
    ds_read_b128 v[24:27], v3 offset:5376
    ds_read_b128 v[28:31], v3 offset:5392
    s_lshl_b32 s38, s4, 16
    s_mov_b32 s20, s68
    s_mov_b32 s21, s69
    s_mov_b32 s22, 1835008
    s_mov_b32 s23, 0x20000
    v_lshlrev_b32 v4, 14, v21
    v_lshl_add_u32 v4, v20, 4, v4
    s_waitcnt lgkmcnt(0)
    buffer_load_dwordx4 v[64:67], v4, s[20:23], s38 offen offset:0 nt
    buffer_load_dwordx4 v[68:71], v4, s[20:23], s38 offen offset:256 nt
    buffer_load_dwordx4 v[72:75], v4, s[20:23], s38 offen offset:512 nt
    buffer_load_dwordx4 v[76:79], v4, s[20:23], s38 offen offset:768 nt
    buffer_load_dwordx4 v[80:83], v4, s[20:23], s38 offen offset:1024 nt
    buffer_load_dwordx4 v[84:87], v4, s[20:23], s38 offen offset:1280 nt
    buffer_load_dwordx4 v[88:91], v4, s[20:23], s38 offen offset:1536 nt
    buffer_load_dwordx4 v[92:95], v4, s[20:23], s38 offen offset:1792 nt
    buffer_load_dwordx4 v[96:99], v4, s[20:23], s38 offen offset:2048 nt
    buffer_load_dwordx4 v[100:103], v4, s[20:23], s38 offen offset:2304 nt
    buffer_load_dwordx4 v[104:107], v4, s[20:23], s38 offen offset:2560 nt
    buffer_load_dwordx4 v[108:111], v4, s[20:23], s38 offen offset:2816 nt
    buffer_load_dwordx4 v[112:115], v4, s[20:23], s38 offen offset:3072 nt
    buffer_load_dwordx4 v[116:119], v4, s[20:23], s38 offen offset:3328 nt
    buffer_load_dwordx4 v[120:123], v4, s[20:23], s38 offen offset:3584 nt
    buffer_load_dwordx4 v[124:127], v4, s[20:23], s38 offen offset:3840 nt
    s_add_u32 s38, s38, 4096
    v_perm_b32 v7, v24, v24, s42
    v_and_b32 v32, v7, v16
    v_and_b32 v33, v7, v17
    v_and_b32 v34, v7, v18
    v_and_b32 v35, v7, v19
    s_waitcnt vmcnt(12)
    s_nop 0
    v_mfma_f32_16x16x32_bf16 v[128:131], v[32:35], v[64:67], 0
    v_mfma_f32_16x16x32_bf16 v[132:135], v[32:35], v[68:71], 0
    v_mfma_f32_16x16x32_bf16 v[136:139], v[32:35], v[72:75], 0
    v_mfma_f32_16x16x32_bf16 v[140:143], v[32:35], v[76:79], 0
    v_perm_b32 v7, v24, v24, s43
    v_and_b32 v36, v7, v16
    v_and_b32 v37, v7, v17
    v_and_b32 v38, v7, v18
    v_and_b32 v39, v7, v19
    s_waitcnt vmcnt(8)
    s_nop 0
    v_mfma_f32_16x16x32_bf16 v[128:131], v[36:39], v[80:83], v[128:131]
    v_mfma_f32_16x16x32_bf16 v[132:135], v[36:39], v[84:87], v[132:135]
    v_mfma_f32_16x16x32_bf16 v[136:139], v[36:39], v[88:91], v[136:139]
    v_mfma_f32_16x16x32_bf16 v[140:143], v[36:39], v[92:95], v[140:143]
    v_perm_b32 v7, v25, v25, s42
    v_and_b32 v32, v7, v16
    v_and_b32 v33, v7, v17
    v_and_b32 v34, v7, v18
    v_and_b32 v35, v7, v19
    s_waitcnt vmcnt(4)
    s_nop 0
    v_mfma_f32_16x16x32_bf16 v[128:131], v[32:35], v[96:99], v[128:131]
    v_mfma_f32_16x16x32_bf16 v[132:135], v[32:35], v[100:103], v[132:135]
    v_mfma_f32_16x16x32_bf16 v[136:139], v[32:35], v[104:107], v[136:139]
    v_mfma_f32_16x16x32_bf16 v[140:143], v[32:35], v[108:111], v[140:143]
    v_perm_b32 v7, v25, v25, s43
    v_and_b32 v36, v7, v16
    v_and_b32 v37, v7, v17
    v_and_b32 v38, v7, v18
    v_and_b32 v39, v7, v19
    s_waitcnt vmcnt(0)
    s_nop 0
    v_mfma_f32_16x16x32_bf16 v[128:131], v[36:39], v[112:115], v[128:131]
    v_mfma_f32_16x16x32_bf16 v[132:135], v[36:39], v[116:119], v[132:135]
    v_mfma_f32_16x16x32_bf16 v[136:139], v[36:39], v[120:123], v[136:139]
    v_mfma_f32_16x16x32_bf16 v[140:143], v[36:39], v[124:127], v[140:143]
    buffer_load_dwordx4 v[64:67], v4, s[20:23], s38 offen offset:0 nt
    buffer_load_dwordx4 v[68:71], v4, s[20:23], s38 offen offset:256 nt
    buffer_load_dwordx4 v[72:75], v4, s[20:23], s38 offen offset:512 nt
    buffer_load_dwordx4 v[76:79], v4, s[20:23], s38 offen offset:768 nt
    buffer_load_dwordx4 v[80:83], v4, s[20:23], s38 offen offset:1024 nt
    buffer_load_dwordx4 v[84:87], v4, s[20:23], s38 offen offset:1280 nt
    buffer_load_dwordx4 v[88:91], v4, s[20:23], s38 offen offset:1536 nt
    buffer_load_dwordx4 v[92:95], v4, s[20:23], s38 offen offset:1792 nt
    buffer_load_dwordx4 v[96:99], v4, s[20:23], s38 offen offset:2048 nt
    buffer_load_dwordx4 v[100:103], v4, s[20:23], s38 offen offset:2304 nt
    buffer_load_dwordx4 v[104:107], v4, s[20:23], s38 offen offset:2560 nt
    buffer_load_dwordx4 v[108:111], v4, s[20:23], s38 offen offset:2816 nt
    buffer_load_dwordx4 v[112:115], v4, s[20:23], s38 offen offset:3072 nt
    buffer_load_dwordx4 v[116:119], v4, s[20:23], s38 offen offset:3328 nt
    buffer_load_dwordx4 v[120:123], v4, s[20:23], s38 offen offset:3584 nt
    buffer_load_dwordx4 v[124:127], v4, s[20:23], s38 offen offset:3840 nt
    s_add_u32 s38, s38, 4096
    v_perm_b32 v7, v26, v26, s42
    v_and_b32 v32, v7, v16
    v_and_b32 v33, v7, v17
    v_and_b32 v34, v7, v18
    v_and_b32 v35, v7, v19
    s_waitcnt vmcnt(12)
    s_nop 0
    v_mfma_f32_16x16x32_bf16 v[128:131], v[32:35], v[64:67], v[128:131]
    v_mfma_f32_16x16x32_bf16 v[132:135], v[32:35], v[68:71], v[132:135]
    v_mfma_f32_16x16x32_bf16 v[136:139], v[32:35], v[72:75], v[136:139]
    v_mfma_f32_16x16x32_bf16 v[140:143], v[32:35], v[76:79], v[140:143]
    v_perm_b32 v7, v26, v26, s43
    v_and_b32 v36, v7, v16
    v_and_b32 v37, v7, v17
    v_and_b32 v38, v7, v18
    v_and_b32 v39, v7, v19
    s_waitcnt vmcnt(8)
    s_nop 0
    v_mfma_f32_16x16x32_bf16 v[128:131], v[36:39], v[80:83], v[128:131]
    v_mfma_f32_16x16x32_bf16 v[132:135], v[36:39], v[84:87], v[132:135]
    v_mfma_f32_16x16x32_bf16 v[136:139], v[36:39], v[88:91], v[136:139]
    v_mfma_f32_16x16x32_bf16 v[140:143], v[36:39], v[92:95], v[140:143]
    v_perm_b32 v7, v27, v27, s42
    v_and_b32 v32, v7, v16
    v_and_b32 v33, v7, v17
    v_and_b32 v34, v7, v18
    v_and_b32 v35, v7, v19
    s_waitcnt vmcnt(4)
    s_nop 0
    v_mfma_f32_16x16x32_bf16 v[128:131], v[32:35], v[96:99], v[128:131]
    v_mfma_f32_16x16x32_bf16 v[132:135], v[32:35], v[100:103], v[132:135]
    v_mfma_f32_16x16x32_bf16 v[136:139], v[32:35], v[104:107], v[136:139]
    v_mfma_f32_16x16x32_bf16 v[140:143], v[32:35], v[108:111], v[140:143]
    v_perm_b32 v7, v27, v27, s43
    v_and_b32 v36, v7, v16
    v_and_b32 v37, v7, v17
    v_and_b32 v38, v7, v18
    v_and_b32 v39, v7, v19
    s_waitcnt vmcnt(0)
    s_nop 0
    v_mfma_f32_16x16x32_bf16 v[128:131], v[36:39], v[112:115], v[128:131]
    v_mfma_f32_16x16x32_bf16 v[132:135], v[36:39], v[116:119], v[132:135]
    v_mfma_f32_16x16x32_bf16 v[136:139], v[36:39], v[120:123], v[136:139]
    v_mfma_f32_16x16x32_bf16 v[140:143], v[36:39], v[124:127], v[140:143]
    buffer_load_dwordx4 v[64:67], v4, s[20:23], s38 offen offset:0 nt
    buffer_load_dwordx4 v[68:71], v4, s[20:23], s38 offen offset:256 nt
    buffer_load_dwordx4 v[72:75], v4, s[20:23], s38 offen offset:512 nt
    buffer_load_dwordx4 v[76:79], v4, s[20:23], s38 offen offset:768 nt
    buffer_load_dwordx4 v[80:83], v4, s[20:23], s38 offen offset:1024 nt
    buffer_load_dwordx4 v[84:87], v4, s[20:23], s38 offen offset:1280 nt
    buffer_load_dwordx4 v[88:91], v4, s[20:23], s38 offen offset:1536 nt
    buffer_load_dwordx4 v[92:95], v4, s[20:23], s38 offen offset:1792 nt
    buffer_load_dwordx4 v[96:99], v4, s[20:23], s38 offen offset:2048 nt
    buffer_load_dwordx4 v[100:103], v4, s[20:23], s38 offen offset:2304 nt
    buffer_load_dwordx4 v[104:107], v4, s[20:23], s38 offen offset:2560 nt
    buffer_load_dwordx4 v[108:111], v4, s[20:23], s38 offen offset:2816 nt
    buffer_load_dwordx4 v[112:115], v4, s[20:23], s38 offen offset:3072 nt
    buffer_load_dwordx4 v[116:119], v4, s[20:23], s38 offen offset:3328 nt
    buffer_load_dwordx4 v[120:123], v4, s[20:23], s38 offen offset:3584 nt
    buffer_load_dwordx4 v[124:127], v4, s[20:23], s38 offen offset:3840 nt
    s_add_u32 s38, s38, 4096
    v_perm_b32 v7, v28, v28, s42
    v_and_b32 v32, v7, v16
    v_and_b32 v33, v7, v17
    v_and_b32 v34, v7, v18
    v_and_b32 v35, v7, v19
    s_waitcnt vmcnt(12)
    s_nop 0
    v_mfma_f32_16x16x32_bf16 v[128:131], v[32:35], v[64:67], v[128:131]
    v_mfma_f32_16x16x32_bf16 v[132:135], v[32:35], v[68:71], v[132:135]
    v_mfma_f32_16x16x32_bf16 v[136:139], v[32:35], v[72:75], v[136:139]
    v_mfma_f32_16x16x32_bf16 v[140:143], v[32:35], v[76:79], v[140:143]
    v_perm_b32 v7, v28, v28, s43
    v_and_b32 v36, v7, v16
    v_and_b32 v37, v7, v17
    v_and_b32 v38, v7, v18
    v_and_b32 v39, v7, v19
    s_waitcnt vmcnt(8)
    s_nop 0
    v_mfma_f32_16x16x32_bf16 v[128:131], v[36:39], v[80:83], v[128:131]
    v_mfma_f32_16x16x32_bf16 v[132:135], v[36:39], v[84:87], v[132:135]
    v_mfma_f32_16x16x32_bf16 v[136:139], v[36:39], v[88:91], v[136:139]
    v_mfma_f32_16x16x32_bf16 v[140:143], v[36:39], v[92:95], v[140:143]
    v_perm_b32 v7, v29, v29, s42
    v_and_b32 v32, v7, v16
    v_and_b32 v33, v7, v17
    v_and_b32 v34, v7, v18
    v_and_b32 v35, v7, v19
    s_waitcnt vmcnt(4)
    s_nop 0
    v_mfma_f32_16x16x32_bf16 v[128:131], v[32:35], v[96:99], v[128:131]
    v_mfma_f32_16x16x32_bf16 v[132:135], v[32:35], v[100:103], v[132:135]
    v_mfma_f32_16x16x32_bf16 v[136:139], v[32:35], v[104:107], v[136:139]
    v_mfma_f32_16x16x32_bf16 v[140:143], v[32:35], v[108:111], v[140:143]
    v_perm_b32 v7, v29, v29, s43
    v_and_b32 v36, v7, v16
    v_and_b32 v37, v7, v17
    v_and_b32 v38, v7, v18
    v_and_b32 v39, v7, v19
    s_waitcnt vmcnt(0)
    s_nop 0
    v_mfma_f32_16x16x32_bf16 v[128:131], v[36:39], v[112:115], v[128:131]
    v_mfma_f32_16x16x32_bf16 v[132:135], v[36:39], v[116:119], v[132:135]
    v_mfma_f32_16x16x32_bf16 v[136:139], v[36:39], v[120:123], v[136:139]
    v_mfma_f32_16x16x32_bf16 v[140:143], v[36:39], v[124:127], v[140:143]
    buffer_load_dwordx4 v[64:67], v4, s[20:23], s38 offen offset:0 nt
    buffer_load_dwordx4 v[68:71], v4, s[20:23], s38 offen offset:256 nt
    buffer_load_dwordx4 v[72:75], v4, s[20:23], s38 offen offset:512 nt
    buffer_load_dwordx4 v[76:79], v4, s[20:23], s38 offen offset:768 nt
    buffer_load_dwordx4 v[80:83], v4, s[20:23], s38 offen offset:1024 nt
    buffer_load_dwordx4 v[84:87], v4, s[20:23], s38 offen offset:1280 nt
    buffer_load_dwordx4 v[88:91], v4, s[20:23], s38 offen offset:1536 nt
    buffer_load_dwordx4 v[92:95], v4, s[20:23], s38 offen offset:1792 nt
    buffer_load_dwordx4 v[96:99], v4, s[20:23], s38 offen offset:2048 nt
    buffer_load_dwordx4 v[100:103], v4, s[20:23], s38 offen offset:2304 nt
    buffer_load_dwordx4 v[104:107], v4, s[20:23], s38 offen offset:2560 nt
    buffer_load_dwordx4 v[108:111], v4, s[20:23], s38 offen offset:2816 nt
    buffer_load_dwordx4 v[112:115], v4, s[20:23], s38 offen offset:3072 nt
    buffer_load_dwordx4 v[116:119], v4, s[20:23], s38 offen offset:3328 nt
    buffer_load_dwordx4 v[120:123], v4, s[20:23], s38 offen offset:3584 nt
    buffer_load_dwordx4 v[124:127], v4, s[20:23], s38 offen offset:3840 nt
    s_add_u32 s38, s38, 4096
    v_perm_b32 v7, v30, v30, s42
    v_and_b32 v32, v7, v16
    v_and_b32 v33, v7, v17
    v_and_b32 v34, v7, v18
    v_and_b32 v35, v7, v19
    s_waitcnt vmcnt(12)
    s_nop 0
    v_mfma_f32_16x16x32_bf16 v[128:131], v[32:35], v[64:67], v[128:131]
    v_mfma_f32_16x16x32_bf16 v[132:135], v[32:35], v[68:71], v[132:135]
    v_mfma_f32_16x16x32_bf16 v[136:139], v[32:35], v[72:75], v[136:139]
    v_mfma_f32_16x16x32_bf16 v[140:143], v[32:35], v[76:79], v[140:143]
    v_perm_b32 v7, v30, v30, s43
    v_and_b32 v36, v7, v16
    v_and_b32 v37, v7, v17
    v_and_b32 v38, v7, v18
    v_and_b32 v39, v7, v19
    s_waitcnt vmcnt(8)
    s_nop 0
    v_mfma_f32_16x16x32_bf16 v[128:131], v[36:39], v[80:83], v[128:131]
    v_mfma_f32_16x16x32_bf16 v[132:135], v[36:39], v[84:87], v[132:135]
    v_mfma_f32_16x16x32_bf16 v[136:139], v[36:39], v[88:91], v[136:139]
    v_mfma_f32_16x16x32_bf16 v[140:143], v[36:39], v[92:95], v[140:143]
    v_perm_b32 v7, v31, v31, s42
    v_and_b32 v32, v7, v16
    v_and_b32 v33, v7, v17
    v_and_b32 v34, v7, v18
    v_and_b32 v35, v7, v19
    s_waitcnt vmcnt(4)
    s_nop 0
    v_mfma_f32_16x16x32_bf16 v[128:131], v[32:35], v[96:99], v[128:131]
    v_mfma_f32_16x16x32_bf16 v[132:135], v[32:35], v[100:103], v[132:135]
    v_mfma_f32_16x16x32_bf16 v[136:139], v[32:35], v[104:107], v[136:139]
    v_mfma_f32_16x16x32_bf16 v[140:143], v[32:35], v[108:111], v[140:143]
    v_perm_b32 v7, v31, v31, s43
    v_and_b32 v36, v7, v16
    v_and_b32 v37, v7, v17
    v_and_b32 v38, v7, v18
    v_and_b32 v39, v7, v19
    s_waitcnt vmcnt(0)
    s_nop 0
    v_mfma_f32_16x16x32_bf16 v[128:131], v[36:39], v[112:115], v[128:131]
    v_mfma_f32_16x16x32_bf16 v[132:135], v[36:39], v[116:119], v[132:135]
    v_mfma_f32_16x16x32_bf16 v[136:139], v[36:39], v[120:123], v[136:139]
    v_mfma_f32_16x16x32_bf16 v[140:143], v[36:39], v[124:127], v[140:143]
    v_lshrrev_b32 v4, 1, v20
    v_lshlrev_b32 v4, 16, v4
    v_and_b32 v5, 1, v20
    v_lshl_add_u32 v4, v5, 6, v4
    v_lshl_add_u32 v4, v21, 5, v4
    s_lshl_b32 s38, s4, 7
    s_add_u32 s38, s38, 1081344
    s_nop 2
    v_mov_b32 v8, v128
    v_mov_b32 v10, v129
    v_mov_b32 v12, v130
    v_mov_b32 v14, v131
    s_mov_b32 exec_hi, 0
    buffer_store_dwordx4 v[8:11], v4, s[16:19], s38 offen sc1
    buffer_store_dwordx4 v[12:15], v4, s[16:19], s38 offen offset:16 sc1
    s_mov_b64 exec, -1
    s_nop 1
    s_add_u32 s38, s38, 524288
    v_mov_b32 v8, v132
    v_mov_b32 v10, v133
    v_mov_b32 v12, v134
    v_mov_b32 v14, v135
    s_mov_b32 exec_hi, 0
    buffer_store_dwordx4 v[8:11], v4, s[16:19], s38 offen sc1
    buffer_store_dwordx4 v[12:15], v4, s[16:19], s38 offen offset:16 sc1
    s_mov_b64 exec, -1
    s_nop 1
    s_add_u32 s38, s38, 524288
    v_mov_b32 v8, v136
    v_mov_b32 v10, v137
    v_mov_b32 v12, v138
    v_mov_b32 v14, v139
    s_mov_b32 exec_hi, 0
    buffer_store_dwordx4 v[8:11], v4, s[16:19], s38 offen sc1
    buffer_store_dwordx4 v[12:15], v4, s[16:19], s38 offen offset:16 sc1
    s_mov_b64 exec, -1
    s_nop 1
    s_add_u32 s38, s38, 524288
    v_mov_b32 v8, v140
    v_mov_b32 v10, v141
    v_mov_b32 v12, v142
    v_mov_b32 v14, v143
    s_mov_b32 exec_hi, 0
    buffer_store_dwordx4 v[8:11], v4, s[16:19], s38 offen sc1
    buffer_store_dwordx4 v[12:15], v4, s[16:19], s38 offen offset:16 sc1
    s_mov_b64 exec, -1
    s_nop 1
L_noffn:
L_end:
    s_endpgm
.section .rodata,"a"
.p2align 6
.amdhsa_kernel parallel_sum__mha_block_cached__glu_gated_reglu__decode_kernel
  .amdhsa_next_free_vgpr 256
  .amdhsa_next_free_sgpr 102
  .amdhsa_accum_offset 256
  .amdhsa_group_segment_fixed_size 0
  .amdhsa_kernarg_size 96
  .amdhsa_user_sgpr_count 2
  .amdhsa_user_sgpr_kernarg_segment_ptr 1
  .amdhsa_system_sgpr_workgroup_id_x 1
.end_amdhsa_kernel
```
